```python
import torch

def _softmax(x, axis=-1):
    return torch.softmax(x, dim=axis)
def _gelu(x):
    return torch.nn.functional.gelu(x, approximate="tanh")
def _silu(x):
    return torch.nn.functional.silu(x)
def _sigmoid(x):
    return torch.sigmoid(x)
def _layernorm(x, axis=-1, eps=1e-5):
    m = x.mean(dim=axis, keepdim=True)
    v = x.var(dim=axis, keepdim=True, unbiased=False)
    return (x - m) / torch.sqrt(v + eps)
def _scatter_add(tgt, idx, src, axis=0):
    return tgt.clone().index_add_(axis, idx, src)
def _segment_sum(src, seg, n):
    out = torch.zeros((n,) + src.shape[1:], dtype=src.dtype)
    return out.index_add_(0, seg, src)
def _pad(x, pw):
    flat = tuple(v for pair in reversed(pw) for v in pair)
    return torch.nn.functional.pad(x, flat)

kernel_name = 'recurrent_scan__softmax_full_mha__mixer_channel_mlp__prompt'

def setup_inputs():

    _w = (lambda a: (lambda t: t.to(torch.bfloat16) if t.is_floating_point() else t)(torch.as_tensor(a)))
    def _A_setup():
        B, S, D = 1, 2048, 640
        return {
            "x": _w((lambda *s: torch.randn(*s, dtype=torch.bfloat16) * 0.05)(B, S, D)),
            "wqkv": _w((lambda *s: torch.randn(*s, dtype=torch.bfloat16) * 0.05)(D, 3 * D)),
            "wo": _w((lambda *s: torch.randn(*s, dtype=torch.bfloat16) * 0.05)(D, D)),
        }
    _A_in = _A_setup()

    def _B_setup():
        B, S, D, F = 1, 2048, 640, 1728
        return {
            "x": _w((lambda *s: torch.randn(*s, dtype=torch.bfloat16) * 0.05)(B, S, D)),
            "w1": _w((lambda *s: torch.randn(*s, dtype=torch.bfloat16) * 3.2)(D, F) * (D ** -0.5)),
            "b1": _w((lambda *s: torch.randn(*s, dtype=torch.bfloat16) * 1.6)(F)),
            "w2": _w((lambda *s: torch.randn(*s, dtype=torch.bfloat16) * 0.05)(F, D) * (F ** -0.5)),
            "b2": _w((lambda *s: torch.randn(*s, dtype=torch.bfloat16) * 0.05)(D)),
        }
    _B_in = _B_setup()

    return {
        "A_x": _A_in["x"],
        "A_wqkv": _A_in["wqkv"],
        "A_wo": _A_in["wo"],
        "B_x": _B_in["x"],
        "B_w1": _B_in["w1"],
        "B_b1": _B_in["b1"],
        "B_w2": _B_in["w2"],
        "B_b2": _B_in["b2"],
    }

def reference(A_x, A_wqkv, A_wo, B_x, B_w1, B_b1, B_w2, B_b2):
    def _A_ref(x, wqkv, wo):
        B, S, D = x.shape
        H = 32; Dh = D // H
        qkv = (lambda x, *d: x.permute(*d))((x @ wqkv).reshape(B, S, 3, H, Dh), 2, 0, 3, 1, 4)
        q, k, v = qkv[0], qkv[1], qkv[2]
        scale = Dh ** -0.5
        scores = torch.einsum("bhqd,bhkd->bhqk", q, k) * scale
        p = _softmax(scores, axis=-1)
        o = torch.einsum("bhqk,bhkd->bhqd", p, v)
        return (lambda x, *d: x.permute(*d))(o, 0, 2, 1, 3).reshape(B, S, D) @ wo

    def _B_ref(x, w1, b1, w2, b2):
        y = _layernorm(x, axis=-1)
        h = _gelu(torch.einsum("bsd,df->bsf", y, w1) + b1)
        return torch.einsum("bsf,fd->bsd", h, w2) + b2

    x = A_x
    xn = _layernorm(x, axis=-1)
    s = _A_ref(xn, A_wqkv, A_wo)
    g = _silu(_B_ref(xn, B_w1, B_b1, B_w2, B_b2))
    return x + s * g
```

```asm
; @launch kernel=gemm1_kernel grid=(256,1,1) block=(1024,1,1) lds=152896
; @launch kernel=attn_kernel grid=(416,1,1) block=(512,1,1) lds=62112
; @launch kernel=out_kernel grid=(160,1,1) block=(768,1,1) lds=147456
.amdgcn_target "amdgcn-amd-amdhsa--gfx950"
.text
.p2align 8
.globl gemm1_kernel
.type gemm1_kernel,@function
gemm1_kernel:
    s_cmp_ge_u32 s2, 256
    s_cbranch_scc1 k1_done
    s_load_dwordx2 s[4:5], s[0:1], 80
    s_load_dwordx2 s[6:7], s[0:1], 8
    s_load_dwordx2 s[8:9], s[0:1], 32
    s_load_dwordx2 s[10:11], s[0:1], 40
    s_load_dwordx2 s[60:61], s[0:1], 0
    s_load_dwordx2 s[62:63], s[0:1], 72
    v_lshrrev_b32 v1, 6, v0
    v_and_b32 v0, 63, v0
    s_and_b32 s20, s2, 7
    v_readfirstlane_b32 s24, v1
    s_lshr_b32 s21, s2, 3
    s_and_b32 s22, s21, 3
    s_lshr_b32 s21, s21, 2
    s_lshr_b32 s26, s20, 2
    s_bfe_u32 s23, s20, 0x10001
    s_lshl_b32 s23, s23, 2
    s_add_u32 s23, s23, s22
    s_and_b32 s27, s20, 1
    s_cmp_eq_u32 s26, 0
    s_cselect_b32 s25, 8, 7
    s_mul_i32 s25, s25, s27
    s_add_u32 s25, s25, s21
    s_lshl_b32 s28, s25, 8
    s_waitcnt lgkmcnt(0)
    s_mov_b32 s36, s4
    s_and_b32 s37, s5, 0xffff
    s_mov_b32 s38, 268435456
    s_mov_b32 s39, 0x00020000
    s_mov_b32 s12, s60
    s_and_b32 s13, s61, 0xffff
    s_mov_b32 s14, 2621440
    s_mov_b32 s15, 0x00020000
    s_mov_b32 s64, s62
    s_and_b32 s65, s63, 0xffff
    s_mov_b32 s66, 256
    s_mov_b32 s67, 0x00020000
    s_xor_b32 s56, s24, 12
    s_or_b32 s56, s56, s2
    s_cmp_lg_u32 s56, 0
    s_cbranch_scc1 k1_nn
    s_memrealtime s[56:57]
    v_mov_b32 v5, 0
    s_waitcnt lgkmcnt(0)
    s_or_b32 s56, s56, 1
    v_mov_b32 v7, s56
    s_mov_b64 exec, 1
    buffer_store_dword v7, v5, s[64:67], 0 offen sc0 sc1
    s_mov_b64 exec, -1
k1_nn:
    s_cmp_eq_u32 s26, 0
    s_cselect_b32 s31, 15, 14
    s_cselect_b32 s32, 8, 7
    s_cmp_ge_u32 s25, s31
    s_cbranch_scc1 k1_pf
    s_cmp_ge_u32 s21, s32
    s_cbranch_scc1 k1_pf
    s_cmp_eq_u32 s26, 0
    s_cselect_b32 s35, 0, 15
    s_add_u32 s35, s35, s25
    s_branch k1_gemm
k1_pf:
    s_load_dwordx2 s[40:41], s[0:1], 48
    s_load_dwordx2 s[42:43], s[0:1], 16
    s_lshr_b32 s30, s20, 1
    s_sub_u32 s31, s20, 2
    s_cmp_lt_u32 s20, 4
    s_cselect_b32 s30, s30, s31
    s_lshl_b32 s30, s30, 2
    s_add_u32 s30, s30, s22
    s_lshl_b32 s30, s30, 4
    s_add_u32 s30, s30, s24
    v_lshlrev_b32 v2, 4, v0
    s_waitcnt lgkmcnt(0)
    s_mov_b32 s16, s40
    s_and_b32 s17, s41, 0xffff
    s_mov_b32 s18, 2211840
    s_mov_b32 s19, 0x00020000
    s_mov_b32 s44, s42
    s_and_b32 s45, s43, 0xffff
    s_mov_b32 s46, 819200
    s_mov_b32 s47, 0x00020000
    s_lshl_b32 s31, s30, 10
    buffer_load_dwordx4 v[4:7], v2, s[16:19], s31 offen
    s_waitcnt vmcnt(0)
    buffer_load_dwordx4 v[28:31], v2, s[44:47], s31 offen
    s_waitcnt vmcnt(0)
    s_add_u32 s31, s31, 393216
    buffer_load_dwordx4 v[8:11], v2, s[16:19], s31 offen
    s_waitcnt vmcnt(0)
    buffer_load_dwordx4 v[32:35], v2, s[44:47], s31 offen
    s_waitcnt vmcnt(0)
    s_add_u32 s31, s31, 393216
    buffer_load_dwordx4 v[12:15], v2, s[16:19], s31 offen
    s_waitcnt vmcnt(0)
    buffer_load_dwordx4 v[36:39], v2, s[44:47], s31 offen
    s_waitcnt vmcnt(0)
    s_add_u32 s31, s31, 393216
    buffer_load_dwordx4 v[16:19], v2, s[16:19], s31 offen
    s_waitcnt vmcnt(0)
    s_add_u32 s31, s31, 393216
    buffer_load_dwordx4 v[20:23], v2, s[16:19], s31 offen
    s_waitcnt vmcnt(0)
    s_add_u32 s31, s31, 393216
    buffer_load_dwordx4 v[24:27], v2, s[16:19], s31 offen
    s_waitcnt vmcnt(0)
    s_add_u32 s31, s31, 393216
    s_waitcnt vmcnt(0)
    s_branch k1_done
k1_gemm:
    s_cmp_lt_u32 s24, 8
    s_cbranch_scc1 k1_compute
    s_cmp_eq_u32 s26, 0
    s_cselect_b32 s32, s6, s8
    s_cselect_b32 s33, s7, s9
    s_mov_b32 s29, 3456
    s_cselect_b32 s29, 3840, s29
    s_mov_b32 s34, 2211840
    s_cselect_b32 s34, 2457600, s34
    s_add_u32 s16, s32, s28
    s_addc_u32 s17, s33, 0
    s_and_b32 s17, s17, 0xffff
    s_sub_u32 s18, s34, s28
    s_mov_b32 s19, 0x00020000
    s_lshl_b32 s45, s29, 2
    s_and_b32 s30, s24, 3
    s_cmp_ge_u32 s24, 12
    s_cbranch_scc1 k1_sw
    v_lshrrev_b32 v56, 3, v0
    v_mul_u32_u24 v56, 1280, v56
    v_and_b32 v57, 7, v0
    v_lshrrev_b32 v58, 4, v0
    v_xor_b32 v59, v57, v58
    v_lshl_add_u32 v2, v59, 4, v56
    v_xor_b32 v59, 4, v59
    v_lshl_add_u32 v3, v59, 4, v56
    v_lshrrev_b32 v56, 4, v0
    v_bfe_u32 v57, v0, 2, 2
    v_xor_b32 v57, v57, v56
    v_and_b32 v58, 3, v0
    v_lshlrev_b32 v58, 4, v58
    v_lshl_add_u32 v58, v57, 6, v58
    v_mul_lo_u32 v59, v56, s29
    v_add_u32 v4, v59, v58
    s_lshl_b32 s40, s23, 8
    s_lshl_b32 s31, s30, 6
    s_add_u32 s40, s40, s31
    s_mul_i32 s40, s40, 1280
    s_lshl_b32 s41, s30, 4
    s_mul_i32 s41, s41, s29
    s_lshl_b32 s44, s29, 6
    s_lshl_b32 s46, s30, 13
    s_lshl_b32 s47, s30, 12
    s_add_u32 s47, s47, 32768
    s_mov_b32 s42, 0
    s_mov_b32 s50, s40
    s_mov_b32 s51, s41
    s_add_u32 s52, s42, s46
    s_add_u32 s53, s42, s47
    s_add_u32 m0, s52, 0
    s_nop 0
    buffer_load_dwordx4 v2, s[12:15], s50 offen lds
    s_add_u32 m0, s52, 1024
    s_add_u32 s50, s50, 10240
    buffer_load_dwordx4 v3, s[12:15], s50 offen lds
    s_add_u32 m0, s52, 2048
    s_add_u32 s50, s50, 10240
    buffer_load_dwordx4 v2, s[12:15], s50 offen lds
    s_add_u32 m0, s52, 3072
    s_add_u32 s50, s50, 10240
    buffer_load_dwordx4 v3, s[12:15], s50 offen lds
    s_add_u32 m0, s52, 4096
    s_add_u32 s50, s50, 10240
    buffer_load_dwordx4 v2, s[12:15], s50 offen lds
    s_add_u32 m0, s52, 5120
    s_add_u32 s50, s50, 10240
    buffer_load_dwordx4 v3, s[12:15], s50 offen lds
    s_add_u32 m0, s52, 6144
    s_add_u32 s50, s50, 10240
    buffer_load_dwordx4 v2, s[12:15], s50 offen lds
    s_add_u32 m0, s52, 7168
    s_add_u32 s50, s50, 10240
    buffer_load_dwordx4 v3, s[12:15], s50 offen lds
    s_add_u32 m0, s53, 0
    s_nop 0
    buffer_load_dwordx4 v4, s[16:19], s51 offen lds
    s_add_u32 m0, s53, 1024
    s_add_u32 s51, s51, s45
    buffer_load_dwordx4 v4, s[16:19], s51 offen lds
    s_add_u32 m0, s53, 2048
    s_add_u32 s51, s51, s45
    buffer_load_dwordx4 v4, s[16:19], s51 offen lds
    s_add_u32 m0, s53, 3072
    s_add_u32 s51, s51, s45
    buffer_load_dwordx4 v4, s[16:19], s51 offen lds
    s_add_u32 s40, s40, 128
    s_add_u32 s41, s41, s44
    s_add_u32 s42, s42, 49152
    s_cmp_eq_u32 s42, 147456
    s_cselect_b32 s42, 0, s42
    s_mov_b32 s50, s40
    s_mov_b32 s51, s41
    s_add_u32 s52, s42, s46
    s_add_u32 s53, s42, s47
    s_add_u32 m0, s52, 0
    s_nop 0
    buffer_load_dwordx4 v2, s[12:15], s50 offen lds
    s_add_u32 m0, s52, 1024
    s_add_u32 s50, s50, 10240
    buffer_load_dwordx4 v3, s[12:15], s50 offen lds
    s_add_u32 m0, s52, 2048
    s_add_u32 s50, s50, 10240
    buffer_load_dwordx4 v2, s[12:15], s50 offen lds
    s_add_u32 m0, s52, 3072
    s_add_u32 s50, s50, 10240
    buffer_load_dwordx4 v3, s[12:15], s50 offen lds
    s_add_u32 m0, s52, 4096
    s_add_u32 s50, s50, 10240
    buffer_load_dwordx4 v2, s[12:15], s50 offen lds
    s_add_u32 m0, s52, 5120
    s_add_u32 s50, s50, 10240
    buffer_load_dwordx4 v3, s[12:15], s50 offen lds
    s_add_u32 m0, s52, 6144
    s_add_u32 s50, s50, 10240
    buffer_load_dwordx4 v2, s[12:15], s50 offen lds
    s_add_u32 m0, s52, 7168
    s_add_u32 s50, s50, 10240
    buffer_load_dwordx4 v3, s[12:15], s50 offen lds
    s_add_u32 m0, s53, 0
    s_nop 0
    buffer_load_dwordx4 v4, s[16:19], s51 offen lds
    s_add_u32 m0, s53, 1024
    s_add_u32 s51, s51, s45
    buffer_load_dwordx4 v4, s[16:19], s51 offen lds
    s_add_u32 m0, s53, 2048
    s_add_u32 s51, s51, s45
    buffer_load_dwordx4 v4, s[16:19], s51 offen lds
    s_add_u32 m0, s53, 3072
    s_add_u32 s51, s51, s45
    buffer_load_dwordx4 v4, s[16:19], s51 offen lds
    s_add_u32 s40, s40, 128
    s_add_u32 s41, s41, s44
    s_add_u32 s42, s42, 49152
    s_cmp_eq_u32 s42, 147456
    s_cselect_b32 s42, 0, s42
    s_waitcnt vmcnt(12)
    s_barrier
    s_mov_b32 s49, 8
k1_hl:
    s_mov_b32 s50, s40
    s_mov_b32 s51, s41
    s_add_u32 s52, s42, s46
    s_add_u32 s53, s42, s47
    s_add_u32 m0, s52, 0
    s_nop 0
    buffer_load_dwordx4 v2, s[12:15], s50 offen lds
    s_add_u32 m0, s52, 1024
    s_add_u32 s50, s50, 10240
    buffer_load_dwordx4 v3, s[12:15], s50 offen lds
    s_add_u32 m0, s52, 2048
    s_add_u32 s50, s50, 10240
    buffer_load_dwordx4 v2, s[12:15], s50 offen lds
    s_add_u32 m0, s52, 3072
    s_add_u32 s50, s50, 10240
    buffer_load_dwordx4 v3, s[12:15], s50 offen lds
    s_add_u32 m0, s52, 4096
    s_add_u32 s50, s50, 10240
    buffer_load_dwordx4 v2, s[12:15], s50 offen lds
    s_add_u32 m0, s52, 5120
    s_add_u32 s50, s50, 10240
    buffer_load_dwordx4 v3, s[12:15], s50 offen lds
    s_add_u32 m0, s52, 6144
    s_add_u32 s50, s50, 10240
    buffer_load_dwordx4 v2, s[12:15], s50 offen lds
    s_add_u32 m0, s52, 7168
    s_add_u32 s50, s50, 10240
    buffer_load_dwordx4 v3, s[12:15], s50 offen lds
    s_add_u32 m0, s53, 0
    s_nop 0
    buffer_load_dwordx4 v4, s[16:19], s51 offen lds
    s_add_u32 m0, s53, 1024
    s_add_u32 s51, s51, s45
    buffer_load_dwordx4 v4, s[16:19], s51 offen lds
    s_add_u32 m0, s53, 2048
    s_add_u32 s51, s51, s45
    buffer_load_dwordx4 v4, s[16:19], s51 offen lds
    s_add_u32 m0, s53, 3072
    s_add_u32 s51, s51, s45
    buffer_load_dwordx4 v4, s[16:19], s51 offen lds
    s_add_u32 s40, s40, 128
    s_add_u32 s41, s41, s44
    s_add_u32 s42, s42, 49152
    s_cmp_eq_u32 s42, 147456
    s_cselect_b32 s42, 0, s42
    s_waitcnt vmcnt(12)
    s_barrier
    s_sub_u32 s49, s49, 1
    s_cmp_lg_u32 s49, 0
    s_cbranch_scc1 k1_hl
    s_waitcnt vmcnt(0)
    s_barrier
    s_barrier
    s_branch k1_sync
k1_sw:
    v_mov_b32 v5, 0
    v_mov_b32 v6, 150272
    ds_write_b32 v6, v5
    ds_write_b32 v6, v5 offset:4
    s_waitcnt lgkmcnt(0)
    s_barrier
    s_mul_i32 s54, s23, 80
    s_mul_i32 s56, s30, 20
    s_add_u32 s54, s54, s56
    s_mul_i32 s54, s54, s29
    v_lshrrev_b32 v48, 4, v0
    v_mul_lo_u32 v52, v48, s29
    v_and_b32 v51, 15, v0
    v_lshl_add_u32 v52, v51, 4, v52
    buffer_load_dwordx4 v[84:87], v52, s[16:19], s54 offen
    s_add_u32 s54, s54, s45
    buffer_load_dwordx4 v[88:91], v52, s[16:19], s54 offen
    s_add_u32 s54, s54, s45
    buffer_load_dwordx4 v[92:95], v52, s[16:19], s54 offen
    s_add_u32 s54, s54, s45
    buffer_load_dwordx4 v[96:99], v52, s[16:19], s54 offen
    s_add_u32 s54, s54, s45
    buffer_load_dwordx4 v[100:103], v52, s[16:19], s54 offen
    s_add_u32 s54, s54, s45
    s_mul_i32 s54, s35, 9
    s_lshl_b32 s55, s30, 2
    s_add_u32 s54, s54, s55
    s_lshl_b32 s55, s23, 8
    s_add_u32 s55, s55, s54
    s_mul_i32 s56, s55, 1280
    v_mul_u32_u24 v48, 1280, v48
    v_lshl_add_u32 v48, v51, 4, v48
    buffer_load_dwordx4 v[16:19], v48, s[12:15], s56 offen offset:0
    buffer_load_dwordx4 v[20:23], v48, s[12:15], s56 offen offset:256
    buffer_load_dwordx4 v[24:27], v48, s[12:15], s56 offen offset:512
    buffer_load_dwordx4 v[28:31], v48, s[12:15], s56 offen offset:768
    buffer_load_dwordx4 v[32:35], v48, s[12:15], s56 offen offset:1024
    s_cmp_lg_u32 s30, 3
    s_cbranch_scc1 k1_nb
    s_mov_b32 s56, s10
    s_and_b32 s57, s11, 0xffff
    s_mov_b32 s58, 3456
    s_mov_b32 s59, 0x00020000
    v_lshlrev_b32 v59, 4, v0
    s_mov_b32 m0, 150016
    s_mov_b64 exec, 0xffff
    buffer_load_dwordx4 v59, s[56:59], s28 offen lds
    s_mov_b64 exec, -1
k1_nb:
    buffer_load_dword v7, v5, s[64:67], 0 offen sc0 sc1
    s_barrier
    s_waitcnt vmcnt(0)
    v_readfirstlane_b32 s48, v7
    buffer_load_dword v7, v5, s[64:67], 0 offen sc0 sc1
    s_mov_b32 s58, 0x00003f80
    s_mov_b32 s59, 0x3f800000
    v_mov_b32 v40, 0
    v_mov_b32 v41, 0
    v_mov_b32 v42, 0
    v_mov_b32 v43, 0
    v_mov_b32 v44, 0
    v_mov_b32 v45, 0
    v_mov_b32 v46, 0
    v_mov_b32 v47, 0
    v_dot2_f32_bf16 v40, v84, s58, v40
    v_dot2_f32_bf16 v41, v84, s59, v41
    v_dot2_f32_bf16 v42, v85, s58, v42
    v_dot2_f32_bf16 v43, v85, s59, v43
    v_dot2_f32_bf16 v44, v86, s58, v44
    v_dot2_f32_bf16 v45, v86, s59, v45
    v_dot2_f32_bf16 v46, v87, s58, v46
    v_dot2_f32_bf16 v47, v87, s59, v47
    v_dot2_f32_bf16 v40, v88, s58, v40
    v_dot2_f32_bf16 v41, v88, s59, v41
    v_dot2_f32_bf16 v42, v89, s58, v42
    v_dot2_f32_bf16 v43, v89, s59, v43
    v_dot2_f32_bf16 v44, v90, s58, v44
    v_dot2_f32_bf16 v45, v90, s59, v45
    v_dot2_f32_bf16 v46, v91, s58, v46
    v_dot2_f32_bf16 v47, v91, s59, v47
    v_dot2_f32_bf16 v40, v92, s58, v40
    v_dot2_f32_bf16 v41, v92, s59, v41
    v_dot2_f32_bf16 v42, v93, s58, v42
    v_dot2_f32_bf16 v43, v93, s59, v43
    v_dot2_f32_bf16 v44, v94, s58, v44
    v_dot2_f32_bf16 v45, v94, s59, v45
    v_dot2_f32_bf16 v46, v95, s58, v46
    v_dot2_f32_bf16 v47, v95, s59, v47
    v_dot2_f32_bf16 v40, v96, s58, v40
    v_dot2_f32_bf16 v41, v96, s59, v41
    v_dot2_f32_bf16 v42, v97, s58, v42
    v_dot2_f32_bf16 v43, v97, s59, v43
    v_dot2_f32_bf16 v44, v98, s58, v44
    v_dot2_f32_bf16 v45, v98, s59, v45
    v_dot2_f32_bf16 v46, v99, s58, v46
    v_dot2_f32_bf16 v47, v99, s59, v47
    v_dot2_f32_bf16 v40, v100, s58, v40
    v_dot2_f32_bf16 v41, v100, s59, v41
    v_dot2_f32_bf16 v42, v101, s58, v42
    v_dot2_f32_bf16 v43, v101, s59, v43
    v_dot2_f32_bf16 v44, v102, s58, v44
    v_dot2_f32_bf16 v45, v102, s59, v45
    v_dot2_f32_bf16 v46, v103, s58, v46
    v_dot2_f32_bf16 v47, v103, s59, v47
    s_barrier
    s_nop 2
    v_mov_b32 v84, v40
    v_mov_b32 v85, v41
    v_mov_b32 v86, v42
    v_mov_b32 v87, v43
    v_mov_b32 v88, v44
    v_mov_b32 v89, v45
    v_mov_b32 v90, v46
    v_mov_b32 v91, v47
    s_nop 1
    v_permlane32_swap_b32 v40, v84
    v_permlane32_swap_b32 v41, v85
    v_permlane32_swap_b32 v42, v86
    v_permlane32_swap_b32 v43, v87
    v_permlane32_swap_b32 v44, v88
    v_permlane32_swap_b32 v45, v89
    v_permlane32_swap_b32 v46, v90
    v_permlane32_swap_b32 v47, v91
    s_nop 1
    v_add_f32 v40, v40, v84
    v_add_f32 v41, v41, v85
    v_add_f32 v42, v42, v86
    v_add_f32 v43, v43, v87
    v_add_f32 v44, v44, v88
    v_add_f32 v45, v45, v89
    v_add_f32 v46, v46, v90
    v_add_f32 v47, v47, v91
    v_mov_b32 v84, v40
    v_mov_b32 v85, v41
    v_mov_b32 v86, v42
    v_mov_b32 v87, v43
    v_mov_b32 v88, v44
    v_mov_b32 v89, v45
    v_mov_b32 v90, v46
    v_mov_b32 v91, v47
    s_nop 1
    v_permlane16_swap_b32 v40, v84
    v_permlane16_swap_b32 v41, v85
    v_permlane16_swap_b32 v42, v86
    v_permlane16_swap_b32 v43, v87
    v_permlane16_swap_b32 v44, v88
    v_permlane16_swap_b32 v45, v89
    v_permlane16_swap_b32 v46, v90
    v_permlane16_swap_b32 v47, v91
    s_nop 1
    v_add_f32 v40, v40, v84
    v_add_f32 v41, v41, v85
    v_add_f32 v42, v42, v86
    v_add_f32 v43, v43, v87
    v_add_f32 v44, v44, v88
    v_add_f32 v45, v45, v89
    v_add_f32 v46, v46, v90
    v_add_f32 v47, v47, v91
    s_lshl_b32 s56, s30, 9
    v_lshlrev_b32 v51, 5, v51
    v_add_u32 v51, s56, v51
    v_add_u32 v51, 150336, v51
    ds_write_b128 v51, v[40:43]
    ds_write_b128 v51, v[44:47] offset:16
    s_waitcnt lgkmcnt(0)
    s_barrier
    s_mov_b32 s57, 0x3f803f80
    s_cmp_eq_u32 s30, 3
    s_cbranch_scc1 k1_s3a
    v_mov_b32 v49, 0
    v_mov_b32 v50, 0
    v_dot2_f32_bf16 v49, v16, s57, v49
    v_dot2_f32_bf16 v50, v16, v16, v50
    v_dot2_f32_bf16 v49, v17, s57, v49
    v_dot2_f32_bf16 v50, v17, v17, v50
    v_dot2_f32_bf16 v49, v18, s57, v49
    v_dot2_f32_bf16 v50, v18, v18, v50
    v_dot2_f32_bf16 v49, v19, s57, v49
    v_dot2_f32_bf16 v50, v19, v19, v50
    v_dot2_f32_bf16 v49, v20, s57, v49
    v_dot2_f32_bf16 v50, v20, v20, v50
    v_dot2_f32_bf16 v49, v21, s57, v49
    v_dot2_f32_bf16 v50, v21, v21, v50
    v_dot2_f32_bf16 v49, v22, s57, v49
    v_dot2_f32_bf16 v50, v22, v22, v50
    v_dot2_f32_bf16 v49, v23, s57, v49
    v_dot2_f32_bf16 v50, v23, v23, v50
    v_dot2_f32_bf16 v49, v24, s57, v49
    v_dot2_f32_bf16 v50, v24, v24, v50
    v_dot2_f32_bf16 v49, v25, s57, v49
    v_dot2_f32_bf16 v50, v25, v25, v50
    v_dot2_f32_bf16 v49, v26, s57, v49
    v_dot2_f32_bf16 v50, v26, v26, v50
    v_dot2_f32_bf16 v49, v27, s57, v49
    v_dot2_f32_bf16 v50, v27, v27, v50
    v_dot2_f32_bf16 v49, v28, s57, v49
    v_dot2_f32_bf16 v50, v28, v28, v50
    v_dot2_f32_bf16 v49, v29, s57, v49
    v_dot2_f32_bf16 v50, v29, v29, v50
    v_dot2_f32_bf16 v49, v30, s57, v49
    v_dot2_f32_bf16 v50, v30, v30, v50
    v_dot2_f32_bf16 v49, v31, s57, v49
    v_dot2_f32_bf16 v50, v31, v31, v50
    v_dot2_f32_bf16 v49, v32, s57, v49
    v_dot2_f32_bf16 v50, v32, v32, v50
    v_dot2_f32_bf16 v49, v33, s57, v49
    v_dot2_f32_bf16 v50, v33, v33, v50
    v_dot2_f32_bf16 v49, v34, s57, v49
    v_dot2_f32_bf16 v50, v34, v34, v50
    v_dot2_f32_bf16 v49, v35, s57, v49
    v_dot2_f32_bf16 v50, v35, v35, v50
    s_nop 2
    v_add_f32_dpp v49, v49, v49 row_ror:8 row_mask:0xf bank_mask:0xf
    v_add_f32_dpp v50, v50, v50 row_ror:8 row_mask:0xf bank_mask:0xf
    s_nop 0
    v_add_f32_dpp v49, v49, v49 row_ror:4 row_mask:0xf bank_mask:0xf
    v_add_f32_dpp v50, v50, v50 row_ror:4 row_mask:0xf bank_mask:0xf
    s_nop 0
    v_add_f32_dpp v49, v49, v49 row_ror:2 row_mask:0xf bank_mask:0xf
    v_add_f32_dpp v50, v50, v50 row_ror:2 row_mask:0xf bank_mask:0xf
    s_nop 0
    v_add_f32_dpp v49, v49, v49 row_ror:1 row_mask:0xf bank_mask:0xf
    v_add_f32_dpp v50, v50, v50 row_ror:1 row_mask:0xf bank_mask:0xf
    s_nop 0
k1_s3a:
    s_barrier
    s_waitcnt vmcnt(0)
    v_readfirstlane_b32 s56, v7
    s_nop 3
    s_cmp_eq_u32 s48, 0
    s_cselect_b32 s48, s56, s48
    s_cmp_eq_u32 s30, 3
    s_cbranch_scc1 k1_s3
    v_mul_f32 v52, 0x3acccccd, v49
    v_mul_f32 v53, 0x3acccccd, v50
    v_fma_f32 v53, -v52, v52, v53
    v_max_f32 v53, 0, v53
    v_mov_b32 v55, v52
    v_cvt_pk_bf16_f32 v51, v55, v55
    v_lshlrev_b32 v55, 16, v51
    v_mov_b32 v54, v53
    v_cvt_pk_bf16_f32 v51, v54, v54
    v_lshlrev_b32 v54, 16, v51
    v_add_f32 v54, 0x3727c5ac, v54
    v_cvt_pk_bf16_f32 v51, v54, v54
    v_lshlrev_b32 v54, 16, v51
    v_sqrt_f32 v54, v54
    s_nop 0
    v_cvt_pk_bf16_f32 v51, v54, v54
    v_lshlrev_b32 v54, 16, v51
    v_rcp_f32 v17, v54
    v_mov_b32 v16, v55
    v_sub_f32 v20, v52, v55
    v_mul_f32 v20, v20, v17
    v_cvt_pk_bf16_f32 v51, v20, v20
    v_lshlrev_b32 v20, 16, v51
    v_mul_f32 v21, v53, v17
    v_mul_f32 v21, v21, v17
    v_cvt_pk_bf16_f32 v51, v21, v21
    v_lshlrev_b32 v21, 16, v51
    v_add_f32 v21, 0x3727c5ac, v21
    v_cvt_pk_bf16_f32 v51, v21, v21
    v_lshlrev_b32 v21, 16, v51
    v_sqrt_f32 v21, v21
    s_nop 0
    v_cvt_pk_bf16_f32 v51, v21, v21
    v_lshlrev_b32 v21, 16, v51
    v_rcp_f32 v21, v21
    v_fma_f32 v18, v20, v54, v55
    v_mul_f32 v19, v17, v21
    v_and_b32 v52, 15, v0
    v_cmp_eq_u32 vcc, 1, v52
    v_lshrrev_b32 v51, 4, v0
    v_add_u32 v53, s54, v51
    v_cndmask_b32 v16, v16, v18, vcc
    v_cndmask_b32 v17, v17, v19, vcc
    v_mov_b32 v18, s48
    v_mov_b32 v19, s48
    v_cmp_gt_u32 vcc, 256, v53
    s_lshl_b32 s56, s30, 2
    v_add_u32 v53, s56, v51
    v_cmp_gt_u32 s[58:59], 9, v53
    v_lshlrev_b32 v51, 5, v51
    v_lshl_add_u32 v51, v52, 4, v51
    s_lshl_b32 s56, s55, 5
    s_add_u32 s56, s56, 25427968
    s_and_b64 s[58:59], s[58:59], vcc
    s_and_b32 s58, s58, 0x00030003
    s_and_b32 s59, s59, 0x00030003
    s_mov_b64 exec, s[58:59]
    s_cbranch_execz k1_lr0
    buffer_store_dwordx4 v[16:19], v51, s[36:39], s56 offen sc0 sc1
k1_lr0:
    s_mov_b64 exec, -1
    s_branch k1_lj
k1_s3:
    v_lshlrev_b32 v51, 3, v0
    v_add_u32 v48, 150336, v51
    ds_read_b64 v[16:17], v48 offset:0
    ds_read_b64 v[18:19], v48 offset:512
    ds_read_b64 v[20:21], v48 offset:1024
    ds_read_b64 v[22:23], v48 offset:1536
    s_lshl_b32 s56, s35, 3
    s_add_u32 s56, s56, s23
    s_lshl_b32 s56, s56, 10
    s_add_u32 s56, s56, 25493504
    v_lshlrev_b32 v51, 4, v0
    s_waitcnt lgkmcnt(0)
    v_add_f32 v16, v16, v18
    v_add_f32 v17, v17, v19
    v_add_f32 v16, v16, v20
    v_add_f32 v17, v17, v21
    v_add_f32 v16, v16, v22
    v_add_f32 v17, v17, v23
    v_mov_b32 v18, s48
    v_mov_b32 v19, s48
    buffer_store_dwordx4 v[16:19], v51, s[36:39], s56 offen sc0 sc1
k1_lj:
    s_barrier
    s_barrier
    s_barrier
    s_lshl_b32 s54, s23, 8
    s_lshl_b32 s55, s30, 6
    s_add_u32 s54, s54, s55
    s_lshl_b32 s54, s54, 5
    s_lshl_b32 s55, s26, 4
    s_add_u32 s54, s54, s55
    s_add_u32 s54, s54, 25427968
    v_lshlrev_b32 v73, 5, v0
    buffer_load_dwordx4 v[76:79], v73, s[36:39], s54 offen sc0 sc1
    s_lshl_b32 s31, s35, 13
    s_lshl_b32 s55, s30, 8
    s_add_u32 s31, s31, s55
    s_add_u32 s31, s31, 25493504
    v_and_b32 v74, 15, v0
    v_lshlrev_b32 v74, 4, v74
    v_lshrrev_b32 v75, 4, v0
    v_lshl_add_u32 v75, v75, 11, v74
    buffer_load_dwordx4 v[80:83], v75, s[36:39], s31 offen sc0 sc1
    buffer_load_dwordx4 v[84:87], v75, s[36:39], s31 offen offset:1024 sc0 sc1
    s_barrier
    s_waitcnt vmcnt(0)
    v_cmp_ne_u32 vcc, s48, v78
    v_cmp_ne_u32 s[54:55], s48, v82
    v_cmp_ne_u32 s[56:57], s48, v86
    s_nop 3
    s_or_b64 s[54:55], s[54:55], vcc
    s_or_b64 s[54:55], s[54:55], s[56:57]
    s_cmp_eq_u32 s48, 0
    s_cselect_b32 s54, 1, s54
    s_cmp_eq_u64 s[54:55], 0
    s_cselect_b32 s50, 1, 0
    s_cbranch_scc1 k1_rdy1
    s_lshl_b32 s54, s23, 8
    s_lshl_b32 s55, s30, 6
    s_add_u32 s54, s54, s55
    s_lshl_b32 s54, s54, 5
    s_lshl_b32 s55, s26, 4
    s_add_u32 s54, s54, s55
    s_add_u32 s54, s54, 25427968
    v_lshlrev_b32 v73, 5, v0
    buffer_load_dwordx4 v[76:79], v73, s[36:39], s54 offen sc0 sc1
    s_lshl_b32 s31, s35, 13
    s_lshl_b32 s55, s30, 8
    s_add_u32 s31, s31, s55
    s_add_u32 s31, s31, 25493504
    v_and_b32 v74, 15, v0
    v_lshlrev_b32 v74, 4, v74
    v_lshrrev_b32 v75, 4, v0
    v_lshl_add_u32 v75, v75, 11, v74
    buffer_load_dwordx4 v[80:83], v75, s[36:39], s31 offen sc0 sc1
    buffer_load_dwordx4 v[84:87], v75, s[36:39], s31 offen offset:1024 sc0 sc1
    s_barrier
    s_waitcnt vmcnt(0)
    v_cmp_ne_u32 vcc, s48, v78
    v_cmp_ne_u32 s[54:55], s48, v82
    v_cmp_ne_u32 s[56:57], s48, v86
    s_nop 3
    s_or_b64 s[54:55], s[54:55], vcc
    s_or_b64 s[54:55], s[54:55], s[56:57]
    s_cmp_eq_u32 s48, 0
    s_cselect_b32 s54, 1, s54
    s_cmp_eq_u64 s[54:55], 0
    s_cselect_b32 s50, 1, 0
    s_cbranch_scc1 k1_rdy2
    v_mov_b32 v5, 1
    ds_write_b32 v6, v5
    s_waitcnt lgkmcnt(0)
    s_branch k1_t9
k1_rdy1:
    s_lshl_b32 s54, s30, 8
    v_lshlrev_b32 v72, 2, v0
    v_add_u32 v72, s54, v72
    v_add_u32 v72, 147456, v72
    ds_write_b32 v72, v76
    ds_write_b32 v72, v77 offset:1024
    v_add_f32 v80, v80, v84
    v_add_f32 v81, v81, v85
    v_mov_b32 v84, v80
    v_mov_b32 v85, v81
    s_nop 1
    v_permlane32_swap_b32 v80, v84
    v_permlane32_swap_b32 v81, v85
    s_nop 1
    v_add_f32 v80, v80, v84
    v_add_f32 v81, v81, v85
    v_mov_b32 v84, v80
    v_mov_b32 v85, v81
    s_nop 1
    v_permlane16_swap_b32 v80, v84
    v_permlane16_swap_b32 v81, v85
    s_nop 1
    v_add_f32 v80, v80, v84
    v_add_f32 v81, v81, v85
    s_lshl_b32 s54, s30, 7
    v_and_b32 v74, 15, v0
    v_lshlrev_b32 v74, 3, v74
    v_add_u32 v74, s54, v74
    v_add_u32 v74, 149504, v74
    ds_write_b64 v74, v[80:81]
    s_waitcnt lgkmcnt(0)
    s_barrier
    s_branch k1_t9
k1_rdy2:
    s_lshl_b32 s54, s30, 8
    v_lshlrev_b32 v72, 2, v0
    v_add_u32 v72, s54, v72
    v_add_u32 v72, 147456, v72
    ds_write_b32 v72, v76
    ds_write_b32 v72, v77 offset:1024
    v_add_f32 v80, v80, v84
    v_add_f32 v81, v81, v85
    v_mov_b32 v84, v80
    v_mov_b32 v85, v81
    s_nop 1
    v_permlane32_swap_b32 v80, v84
    v_permlane32_swap_b32 v81, v85
    s_nop 1
    v_add_f32 v80, v80, v84
    v_add_f32 v81, v81, v85
    v_mov_b32 v84, v80
    v_mov_b32 v85, v81
    s_nop 1
    v_permlane16_swap_b32 v80, v84
    v_permlane16_swap_b32 v81, v85
    s_nop 1
    v_add_f32 v80, v80, v84
    v_add_f32 v81, v81, v85
    s_lshl_b32 s54, s30, 7
    v_and_b32 v74, 15, v0
    v_lshlrev_b32 v74, 3, v74
    v_add_u32 v74, s54, v74
    v_add_u32 v74, 149504, v74
    ds_write_b64 v74, v[80:81]
    s_waitcnt lgkmcnt(0)
k1_t9:
    s_barrier
    s_branch k1_sync
k1_compute:
    s_lshr_b32 s42, s24, 1
    s_and_b32 s43, s24, 1
    v_lshlrev_b32 v116, 4, v0
    v_lshrrev_b32 v72, 5, v0
    v_and_b32 v73, 31, v0
    v_bfe_u32 v74, v0, 1, 3
    s_lshl_b32 s46, s42, 13
    v_lshlrev_b32 v75, 7, v73
    v_add_u32 v75, s46, v75
    v_add_u32 v76, 0, v72
    v_xor_b32 v76, v76, v74
    v_lshl_add_u32 v104, v76, 4, v75
    v_add_u32 v76, 2, v72
    v_xor_b32 v76, v76, v74
    v_lshl_add_u32 v105, v76, 4, v75
    v_add_u32 v76, 4, v72
    v_xor_b32 v76, v76, v74
    v_lshl_add_u32 v106, v76, 4, v75
    v_add_u32 v76, 6, v72
    v_xor_b32 v76, v76, v74
    v_lshl_add_u32 v107, v76, 4, v75
    v_bfe_u32 v73, v0, 2, 2
    v_mad_u32_u24 v74, v72, 8, v73
    v_lshlrev_b32 v74, 8, v74
    v_bfe_u32 v75, v0, 4, 1
    v_lshl_add_u32 v74, v75, 5, v74
    v_and_b32 v75, 3, v0
    v_lshl_add_u32 v74, v75, 3, v74
    v_add_u32 v74, 32768, v74
    s_lshl_b32 s46, s43, 1
    s_add_u32 s46, s46, 0
    v_xor_b32 v75, s46, v73
    v_lshl_add_u32 v108, v75, 6, v74
    s_lshl_b32 s46, s43, 1
    s_add_u32 s46, s46, 1
    v_xor_b32 v75, s46, v73
    v_lshl_add_u32 v109, v75, 6, v74
    v_mov_b32 v8, 0
    v_mov_b32 v9, 0
    v_mov_b32 v10, 0
    v_mov_b32 v11, 0
    v_mov_b32 v12, 0
    v_mov_b32 v13, 0
    v_mov_b32 v14, 0
    v_mov_b32 v15, 0
    v_mov_b32 v16, 0
    v_mov_b32 v17, 0
    v_mov_b32 v18, 0
    v_mov_b32 v19, 0
    v_mov_b32 v20, 0
    v_mov_b32 v21, 0
    v_mov_b32 v22, 0
    v_mov_b32 v23, 0
    v_mov_b32 v24, 0
    v_mov_b32 v25, 0
    v_mov_b32 v26, 0
    v_mov_b32 v27, 0
    v_mov_b32 v28, 0
    v_mov_b32 v29, 0
    v_mov_b32 v30, 0
    v_mov_b32 v31, 0
    v_mov_b32 v32, 0
    v_mov_b32 v33, 0
    v_mov_b32 v34, 0
    v_mov_b32 v35, 0
    v_mov_b32 v36, 0
    v_mov_b32 v37, 0
    v_mov_b32 v38, 0
    v_mov_b32 v39, 0
    v_mov_b32 v40, 0
    v_mov_b32 v41, 0
    v_mov_b32 v42, 0
    v_mov_b32 v43, 0
    v_mov_b32 v44, 0
    v_mov_b32 v45, 0
    v_mov_b32 v46, 0
    v_mov_b32 v47, 0
    v_mov_b32 v48, 0
    v_mov_b32 v49, 0
    v_mov_b32 v50, 0
    v_mov_b32 v51, 0
    v_mov_b32 v52, 0
    v_mov_b32 v53, 0
    v_mov_b32 v54, 0
    v_mov_b32 v55, 0
    v_mov_b32 v56, 0
    v_mov_b32 v57, 0
    v_mov_b32 v58, 0
    v_mov_b32 v59, 0
    v_mov_b32 v60, 0
    v_mov_b32 v61, 0
    v_mov_b32 v62, 0
    v_mov_b32 v63, 0
    v_mov_b32 v64, 0
    v_mov_b32 v65, 0
    v_mov_b32 v66, 0
    v_mov_b32 v67, 0
    v_mov_b32 v68, 0
    v_mov_b32 v69, 0
    v_mov_b32 v70, 0
    v_mov_b32 v71, 0
    s_mov_b32 s40, 0
    s_cmp_eq_u32 s26, 0
    s_cbranch_scc1 k1_qkv
    v_add_u32 v110, s40, v104
    v_add_u32 v111, s40, v105
    v_add_u32 v112, s40, v106
    v_add_u32 v113, s40, v107
    v_add_u32 v114, s40, v108
    v_add_u32 v115, s40, v109
    s_mov_b32 s41, 10
    s_barrier
    ds_read_b128 v[72:75], v110 offset:0
    ds_read_b64_tr_b16 v[80:81], v114 offset:0
    ds_read_b64_tr_b16 v[82:83], v114 offset:1024
    ds_read_b64_tr_b16 v[84:85], v115 offset:0
    ds_read_b64_tr_b16 v[86:87], v115 offset:1024
    ds_read_b128 v[76:79], v110 offset:4096
k1_mlp_loop:
    s_waitcnt lgkmcnt(3)
    v_mfma_f32_32x32x16_bf16 v[8:23], v[80:83], v[72:75], v[8:23]
    ds_read_b128 v[88:91], v111 offset:0
    ds_read_b64_tr_b16 v[96:97], v114 offset:4096
    ds_read_b64_tr_b16 v[98:99], v114 offset:5120
    s_waitcnt lgkmcnt(4)
    v_mfma_f32_32x32x16_bf16 v[24:39], v[84:87], v[72:75], v[24:39]
    ds_read_b64_tr_b16 v[100:101], v115 offset:4096
    ds_read_b64_tr_b16 v[102:103], v115 offset:5120
    ds_read_b128 v[92:95], v111 offset:4096
    s_waitcnt lgkmcnt(6)
    v_mfma_f32_32x32x16_bf16 v[40:55], v[80:83], v[76:79], v[40:55]
    v_mfma_f32_32x32x16_bf16 v[56:71], v[84:87], v[76:79], v[56:71]
    s_waitcnt lgkmcnt(3)
    v_mfma_f32_32x32x16_bf16 v[8:23], v[96:99], v[88:91], v[8:23]
    ds_read_b128 v[72:75], v112 offset:0
    ds_read_b64_tr_b16 v[80:81], v114 offset:8192
    ds_read_b64_tr_b16 v[82:83], v114 offset:9216
    s_waitcnt lgkmcnt(4)
    v_mfma_f32_32x32x16_bf16 v[24:39], v[100:103], v[88:91], v[24:39]
    ds_read_b64_tr_b16 v[84:85], v115 offset:8192
    ds_read_b64_tr_b16 v[86:87], v115 offset:9216
    ds_read_b128 v[76:79], v112 offset:4096
    s_waitcnt lgkmcnt(6)
    v_mfma_f32_32x32x16_bf16 v[40:55], v[96:99], v[92:95], v[40:55]
    v_mfma_f32_32x32x16_bf16 v[56:71], v[100:103], v[92:95], v[56:71]
    s_waitcnt lgkmcnt(3)
    v_mfma_f32_32x32x16_bf16 v[8:23], v[80:83], v[72:75], v[8:23]
    ds_read_b128 v[88:91], v113 offset:0
    ds_read_b64_tr_b16 v[96:97], v114 offset:12288
    ds_read_b64_tr_b16 v[98:99], v114 offset:13312
    s_waitcnt lgkmcnt(4)
    v_mfma_f32_32x32x16_bf16 v[24:39], v[84:87], v[72:75], v[24:39]
    ds_read_b64_tr_b16 v[100:101], v115 offset:12288
    ds_read_b64_tr_b16 v[102:103], v115 offset:13312
    ds_read_b128 v[92:95], v113 offset:4096
    s_waitcnt lgkmcnt(6)
    v_mfma_f32_32x32x16_bf16 v[40:55], v[80:83], v[76:79], v[40:55]
    v_mfma_f32_32x32x16_bf16 v[56:71], v[84:87], v[76:79], v[56:71]
    s_add_u32 s40, s40, 49152
    s_cmp_eq_u32 s40, 147456
    s_cselect_b32 s40, 0, s40
    s_waitcnt lgkmcnt(0)
    s_barrier
    v_mfma_f32_32x32x16_bf16 v[8:23], v[96:99], v[88:91], v[8:23]
    v_add_u32 v110, s40, v104
    v_add_u32 v111, s40, v105
    v_add_u32 v112, s40, v106
    v_add_u32 v113, s40, v107
    v_add_u32 v114, s40, v108
    v_add_u32 v115, s40, v109
    ds_read_b128 v[72:75], v110 offset:0
    ds_read_b64_tr_b16 v[80:81], v114 offset:0
    ds_read_b64_tr_b16 v[82:83], v114 offset:1024
    v_mfma_f32_32x32x16_bf16 v[24:39], v[100:103], v[88:91], v[24:39]
    ds_read_b64_tr_b16 v[84:85], v115 offset:0
    ds_read_b64_tr_b16 v[86:87], v115 offset:1024
    ds_read_b128 v[76:79], v110 offset:4096
    v_mfma_f32_32x32x16_bf16 v[40:55], v[96:99], v[92:95], v[40:55]
    v_mfma_f32_32x32x16_bf16 v[56:71], v[100:103], v[92:95], v[56:71]
    s_sub_u32 s41, s41, 1
    s_cmp_lg_u32 s41, 0
    s_cbranch_scc1 k1_mlp_loop
    s_waitcnt lgkmcnt(0)
    s_mov_b32 s44, 1
    s_nop 15
    s_branch k1_sync
k1_ret_mlp:
    s_lshl_b32 s46, s43, 6
    s_lshr_b32 s47, s28, 1
    s_add_u32 s52, s46, s47
    s_cmp_ge_u32 s52, 1728
    s_cbranch_scc1 k1_end
    v_and_b32 v108, 31, v0
    s_lshl_b32 s46, s42, 8
    v_lshlrev_b32 v108, 2, v108
    v_add_u32 v108, s46, v108
    v_add_u32 v108, 147456, v108
    ds_read_b32 v104, v108
    ds_read_b32 v105, v108 offset:128
    ds_read_b32 v106, v108 offset:1024
    ds_read_b32 v107, v108 offset:1152
    v_lshrrev_b32 v109, 5, v0
    v_lshlrev_b32 v109, 4, v109
    s_lshl_b32 s46, s43, 8
    v_add_u32 v109, s46, v109
    v_add_u32 v109, 149504, v109
    ds_read_b128 v[72:75], v109 offset:0
    ds_read_b128 v[76:79], v109 offset:32
    ds_read_b128 v[80:83], v109 offset:64
    ds_read_b128 v[84:87], v109 offset:96
    ds_read_b128 v[88:91], v109 offset:128
    ds_read_b128 v[92:95], v109 offset:160
    ds_read_b128 v[96:99], v109 offset:192
    ds_read_b128 v[100:103], v109 offset:224
    s_waitcnt lgkmcnt(4)
    v_fma_f32 v8, -v104, v72, v8
    v_fma_f32 v9, -v104, v73, v9
    v_fma_f32 v10, -v104, v74, v10
    v_fma_f32 v11, -v104, v75, v11
    v_fma_f32 v12, -v104, v76, v12
    v_fma_f32 v13, -v104, v77, v13
    v_fma_f32 v14, -v104, v78, v14
    v_fma_f32 v15, -v104, v79, v15
    v_fma_f32 v16, -v104, v80, v16
    v_fma_f32 v17, -v104, v81, v17
    v_fma_f32 v18, -v104, v82, v18
    v_fma_f32 v19, -v104, v83, v19
    v_fma_f32 v20, -v104, v84, v20
    v_fma_f32 v21, -v104, v85, v21
    v_fma_f32 v22, -v104, v86, v22
    v_fma_f32 v23, -v104, v87, v23
    v_fma_f32 v40, -v105, v72, v40
    v_fma_f32 v41, -v105, v73, v41
    v_fma_f32 v42, -v105, v74, v42
    v_fma_f32 v43, -v105, v75, v43
    v_fma_f32 v44, -v105, v76, v44
    v_fma_f32 v45, -v105, v77, v45
    v_fma_f32 v46, -v105, v78, v46
    v_fma_f32 v47, -v105, v79, v47
    v_fma_f32 v48, -v105, v80, v48
    v_fma_f32 v49, -v105, v81, v49
    v_fma_f32 v50, -v105, v82, v50
    v_fma_f32 v51, -v105, v83, v51
    v_fma_f32 v52, -v105, v84, v52
    v_fma_f32 v53, -v105, v85, v53
    v_fma_f32 v54, -v105, v86, v54
    v_fma_f32 v55, -v105, v87, v55
    s_waitcnt lgkmcnt(0)
    v_fma_f32 v24, -v104, v88, v24
    v_fma_f32 v25, -v104, v89, v25
    v_fma_f32 v26, -v104, v90, v26
    v_fma_f32 v27, -v104, v91, v27
    v_fma_f32 v28, -v104, v92, v28
    v_fma_f32 v29, -v104, v93, v29
    v_fma_f32 v30, -v104, v94, v30
    v_fma_f32 v31, -v104, v95, v31
    v_fma_f32 v32, -v104, v96, v32
    v_fma_f32 v33, -v104, v97, v33
    v_fma_f32 v34, -v104, v98, v34
    v_fma_f32 v35, -v104, v99, v35
    v_fma_f32 v36, -v104, v100, v36
    v_fma_f32 v37, -v104, v101, v37
    v_fma_f32 v38, -v104, v102, v38
    v_fma_f32 v39, -v104, v103, v39
    v_fma_f32 v56, -v105, v88, v56
    v_fma_f32 v57, -v105, v89, v57
    v_fma_f32 v58, -v105, v90, v58
    v_fma_f32 v59, -v105, v91, v59
    v_fma_f32 v60, -v105, v92, v60
    v_fma_f32 v61, -v105, v93, v61
    v_fma_f32 v62, -v105, v94, v62
    v_fma_f32 v63, -v105, v95, v63
    v_fma_f32 v64, -v105, v96, v64
    v_fma_f32 v65, -v105, v97, v65
    v_fma_f32 v66, -v105, v98, v66
    v_fma_f32 v67, -v105, v99, v67
    v_fma_f32 v68, -v105, v100, v68
    v_fma_f32 v69, -v105, v101, v69
    v_fma_f32 v70, -v105, v102, v70
    v_fma_f32 v71, -v105, v103, v71
    v_lshrrev_b32 v108, 5, v0
    v_lshlrev_b32 v108, 3, v108
    s_lshl_b32 s46, s43, 7
    v_add_u32 v108, s46, v108
    v_add_u32 v108, 150016, v108
    ds_read_b64 v[88:89], v108 offset:0
    ds_read_b64 v[90:91], v108 offset:16
    ds_read_b64 v[92:93], v108 offset:32
    ds_read_b64 v[94:95], v108 offset:48
    ds_read_b64 v[96:97], v108 offset:64
    ds_read_b64 v[98:99], v108 offset:80
    ds_read_b64 v[100:101], v108 offset:96
    ds_read_b64 v[102:103], v108 offset:112
    s_waitcnt lgkmcnt(0)
    v_lshlrev_b32 v72, 16, v88
    v_and_b32 v73, 0xffff0000, v88
    v_lshlrev_b32 v74, 16, v89
    v_and_b32 v75, 0xffff0000, v89
    v_fma_f32 v8, v8, v106, v72
    v_fma_f32 v9, v9, v106, v73
    v_fma_f32 v10, v10, v106, v74
    v_fma_f32 v11, v11, v106, v75
    v_fma_f32 v40, v40, v107, v72
    v_fma_f32 v41, v41, v107, v73
    v_fma_f32 v42, v42, v107, v74
    v_fma_f32 v43, v43, v107, v75
    v_lshlrev_b32 v72, 16, v90
    v_and_b32 v73, 0xffff0000, v90
    v_lshlrev_b32 v74, 16, v91
    v_and_b32 v75, 0xffff0000, v91
    v_fma_f32 v12, v12, v106, v72
    v_fma_f32 v13, v13, v106, v73
    v_fma_f32 v14, v14, v106, v74
    v_fma_f32 v15, v15, v106, v75
    v_fma_f32 v44, v44, v107, v72
    v_fma_f32 v45, v45, v107, v73
    v_fma_f32 v46, v46, v107, v74
    v_fma_f32 v47, v47, v107, v75
    v_lshlrev_b32 v72, 16, v92
    v_and_b32 v73, 0xffff0000, v92
    v_lshlrev_b32 v74, 16, v93
    v_and_b32 v75, 0xffff0000, v93
    v_fma_f32 v16, v16, v106, v72
    v_fma_f32 v17, v17, v106, v73
    v_fma_f32 v18, v18, v106, v74
    v_fma_f32 v19, v19, v106, v75
    v_fma_f32 v48, v48, v107, v72
    v_fma_f32 v49, v49, v107, v73
    v_fma_f32 v50, v50, v107, v74
    v_fma_f32 v51, v51, v107, v75
    v_lshlrev_b32 v72, 16, v94
    v_and_b32 v73, 0xffff0000, v94
    v_lshlrev_b32 v74, 16, v95
    v_and_b32 v75, 0xffff0000, v95
    v_fma_f32 v20, v20, v106, v72
    v_fma_f32 v21, v21, v106, v73
    v_fma_f32 v22, v22, v106, v74
    v_fma_f32 v23, v23, v106, v75
    v_fma_f32 v52, v52, v107, v72
    v_fma_f32 v53, v53, v107, v73
    v_fma_f32 v54, v54, v107, v74
    v_fma_f32 v55, v55, v107, v75
    v_lshlrev_b32 v72, 16, v96
    v_and_b32 v73, 0xffff0000, v96
    v_lshlrev_b32 v74, 16, v97
    v_and_b32 v75, 0xffff0000, v97
    v_fma_f32 v24, v24, v106, v72
    v_fma_f32 v25, v25, v106, v73
    v_fma_f32 v26, v26, v106, v74
    v_fma_f32 v27, v27, v106, v75
    v_fma_f32 v56, v56, v107, v72
    v_fma_f32 v57, v57, v107, v73
    v_fma_f32 v58, v58, v107, v74
    v_fma_f32 v59, v59, v107, v75
    v_lshlrev_b32 v72, 16, v98
    v_and_b32 v73, 0xffff0000, v98
    v_lshlrev_b32 v74, 16, v99
    v_and_b32 v75, 0xffff0000, v99
    v_fma_f32 v28, v28, v106, v72
    v_fma_f32 v29, v29, v106, v73
    v_fma_f32 v30, v30, v106, v74
    v_fma_f32 v31, v31, v106, v75
    v_fma_f32 v60, v60, v107, v72
    v_fma_f32 v61, v61, v107, v73
    v_fma_f32 v62, v62, v107, v74
    v_fma_f32 v63, v63, v107, v75
    v_lshlrev_b32 v72, 16, v100
    v_and_b32 v73, 0xffff0000, v100
    v_lshlrev_b32 v74, 16, v101
    v_and_b32 v75, 0xffff0000, v101
    v_fma_f32 v32, v32, v106, v72
    v_fma_f32 v33, v33, v106, v73
    v_fma_f32 v34, v34, v106, v74
    v_fma_f32 v35, v35, v106, v75
    v_fma_f32 v64, v64, v107, v72
    v_fma_f32 v65, v65, v107, v73
    v_fma_f32 v66, v66, v107, v74
    v_fma_f32 v67, v67, v107, v75
    v_lshlrev_b32 v72, 16, v102
    v_and_b32 v73, 0xffff0000, v102
    v_lshlrev_b32 v74, 16, v103
    v_and_b32 v75, 0xffff0000, v103
    v_fma_f32 v36, v36, v106, v72
    v_fma_f32 v37, v37, v106, v73
    v_fma_f32 v38, v38, v106, v74
    v_fma_f32 v39, v39, v106, v75
    v_fma_f32 v68, v68, v107, v72
    v_fma_f32 v69, v69, v107, v73
    v_fma_f32 v70, v70, v107, v74
    v_fma_f32 v71, v71, v107, v75
    s_lshl_b32 s47, s23, 3
    s_lshl_b32 s53, s42, 1
    s_add_u32 s47, s47, s53
    s_lshr_b32 s46, s52, 4
    s_lshl_b32 s46, s46, 6
    s_add_u32 s46, s46, s47
    s_lshl_b32 s46, s46, 10
    s_add_u32 s46, s46, 13107200
    s_add_u32 s47, s46, 65536
    s_add_u32 s48, s46, 131072
    s_add_u32 s49, s46, 196608
    v_mov_b32 v110, 0xc0135761
    v_mov_b32 v111, 0xbdd2d3e8
    v_mul_f32 v72, v8, v8
    v_mul_f32 v73, v9, v9
    v_mul_f32 v74, v10, v10
    v_mul_f32 v75, v11, v11
    v_mul_f32 v76, v12, v12
    v_mul_f32 v77, v13, v13
    v_mul_f32 v78, v14, v14
    v_mul_f32 v79, v15, v15
    v_fma_f32 v72, v72, v111, v110
    v_fma_f32 v73, v73, v111, v110
    v_fma_f32 v74, v74, v111, v110
    v_fma_f32 v75, v75, v111, v110
    v_fma_f32 v76, v76, v111, v110
    v_fma_f32 v77, v77, v111, v110
    v_fma_f32 v78, v78, v111, v110
    v_fma_f32 v79, v79, v111, v110
    v_mul_f32 v72, v72, v8
    v_mul_f32 v73, v73, v9
    v_mul_f32 v74, v74, v10
    v_mul_f32 v75, v75, v11
    v_mul_f32 v76, v76, v12
    v_mul_f32 v77, v77, v13
    v_mul_f32 v78, v78, v14
    v_mul_f32 v79, v79, v15
    v_exp_f32 v72, v72
    v_exp_f32 v73, v73
    v_exp_f32 v74, v74
    v_exp_f32 v75, v75
    v_exp_f32 v76, v76
    v_exp_f32 v77, v77
    v_exp_f32 v78, v78
    v_exp_f32 v79, v79
    v_add_f32 v72, 1.0, v72
    v_add_f32 v73, 1.0, v73
    v_add_f32 v74, 1.0, v74
    v_add_f32 v75, 1.0, v75
    v_add_f32 v76, 1.0, v76
    v_add_f32 v77, 1.0, v77
    v_add_f32 v78, 1.0, v78
    v_add_f32 v79, 1.0, v79
    v_rcp_f32 v72, v72
    v_rcp_f32 v73, v73
    v_rcp_f32 v74, v74
    v_rcp_f32 v75, v75
    v_rcp_f32 v76, v76
    v_rcp_f32 v77, v77
    v_rcp_f32 v78, v78
    v_rcp_f32 v79, v79
    v_mul_f32 v72, v72, v8
    v_mul_f32 v73, v73, v9
    v_mul_f32 v74, v74, v10
    v_mul_f32 v75, v75, v11
    v_mul_f32 v76, v76, v12
    v_mul_f32 v77, v77, v13
    v_mul_f32 v78, v78, v14
    v_mul_f32 v79, v79, v15
    v_cvt_pk_bf16_f32 v88, v72, v73
    v_cvt_pk_bf16_f32 v89, v74, v75
    v_cvt_pk_bf16_f32 v90, v76, v77
    v_cvt_pk_bf16_f32 v91, v78, v79
    buffer_store_dwordx4 v[88:91], v116, s[36:39], s46 offen offset:0 sc0 sc1
    v_mul_f32 v80, v16, v16
    v_mul_f32 v81, v17, v17
    v_mul_f32 v82, v18, v18
    v_mul_f32 v83, v19, v19
    v_mul_f32 v84, v20, v20
    v_mul_f32 v85, v21, v21
    v_mul_f32 v86, v22, v22
    v_mul_f32 v87, v23, v23
    v_fma_f32 v80, v80, v111, v110
    v_fma_f32 v81, v81, v111, v110
    v_fma_f32 v82, v82, v111, v110
    v_fma_f32 v83, v83, v111, v110
    v_fma_f32 v84, v84, v111, v110
    v_fma_f32 v85, v85, v111, v110
    v_fma_f32 v86, v86, v111, v110
    v_fma_f32 v87, v87, v111, v110
    v_mul_f32 v80, v80, v16
    v_mul_f32 v81, v81, v17
    v_mul_f32 v82, v82, v18
    v_mul_f32 v83, v83, v19
    v_mul_f32 v84, v84, v20
    v_mul_f32 v85, v85, v21
    v_mul_f32 v86, v86, v22
    v_mul_f32 v87, v87, v23
    v_exp_f32 v80, v80
    v_exp_f32 v81, v81
    v_exp_f32 v82, v82
    v_exp_f32 v83, v83
    v_exp_f32 v84, v84
    v_exp_f32 v85, v85
    v_exp_f32 v86, v86
    v_exp_f32 v87, v87
    v_add_f32 v80, 1.0, v80
    v_add_f32 v81, 1.0, v81
    v_add_f32 v82, 1.0, v82
    v_add_f32 v83, 1.0, v83
    v_add_f32 v84, 1.0, v84
    v_add_f32 v85, 1.0, v85
    v_add_f32 v86, 1.0, v86
    v_add_f32 v87, 1.0, v87
    v_rcp_f32 v80, v80
    v_rcp_f32 v81, v81
    v_rcp_f32 v82, v82
    v_rcp_f32 v83, v83
    v_rcp_f32 v84, v84
    v_rcp_f32 v85, v85
    v_rcp_f32 v86, v86
    v_rcp_f32 v87, v87
    v_mul_f32 v80, v80, v16
    v_mul_f32 v81, v81, v17
    v_mul_f32 v82, v82, v18
    v_mul_f32 v83, v83, v19
    v_mul_f32 v84, v84, v20
    v_mul_f32 v85, v85, v21
    v_mul_f32 v86, v86, v22
    v_mul_f32 v87, v87, v23
    v_cvt_pk_bf16_f32 v92, v80, v81
    v_cvt_pk_bf16_f32 v93, v82, v83
    v_cvt_pk_bf16_f32 v94, v84, v85
    v_cvt_pk_bf16_f32 v95, v86, v87
    buffer_store_dwordx4 v[92:95], v116, s[36:39], s47 offen offset:0 sc0 sc1
    v_mul_f32 v72, v24, v24
    v_mul_f32 v73, v25, v25
    v_mul_f32 v74, v26, v26
    v_mul_f32 v75, v27, v27
    v_mul_f32 v76, v28, v28
    v_mul_f32 v77, v29, v29
    v_mul_f32 v78, v30, v30
    v_mul_f32 v79, v31, v31
    v_fma_f32 v72, v72, v111, v110
    v_fma_f32 v73, v73, v111, v110
    v_fma_f32 v74, v74, v111, v110
    v_fma_f32 v75, v75, v111, v110
    v_fma_f32 v76, v76, v111, v110
    v_fma_f32 v77, v77, v111, v110
    v_fma_f32 v78, v78, v111, v110
    v_fma_f32 v79, v79, v111, v110
    v_mul_f32 v72, v72, v24
    v_mul_f32 v73, v73, v25
    v_mul_f32 v74, v74, v26
    v_mul_f32 v75, v75, v27
    v_mul_f32 v76, v76, v28
    v_mul_f32 v77, v77, v29
    v_mul_f32 v78, v78, v30
    v_mul_f32 v79, v79, v31
    v_exp_f32 v72, v72
    v_exp_f32 v73, v73
    v_exp_f32 v74, v74
    v_exp_f32 v75, v75
    v_exp_f32 v76, v76
    v_exp_f32 v77, v77
    v_exp_f32 v78, v78
    v_exp_f32 v79, v79
    v_add_f32 v72, 1.0, v72
    v_add_f32 v73, 1.0, v73
    v_add_f32 v74, 1.0, v74
    v_add_f32 v75, 1.0, v75
    v_add_f32 v76, 1.0, v76
    v_add_f32 v77, 1.0, v77
    v_add_f32 v78, 1.0, v78
    v_add_f32 v79, 1.0, v79
    v_rcp_f32 v72, v72
    v_rcp_f32 v73, v73
    v_rcp_f32 v74, v74
    v_rcp_f32 v75, v75
    v_rcp_f32 v76, v76
    v_rcp_f32 v77, v77
    v_rcp_f32 v78, v78
    v_rcp_f32 v79, v79
    v_mul_f32 v72, v72, v24
    v_mul_f32 v73, v73, v25
    v_mul_f32 v74, v74, v26
    v_mul_f32 v75, v75, v27
    v_mul_f32 v76, v76, v28
    v_mul_f32 v77, v77, v29
    v_mul_f32 v78, v78, v30
    v_mul_f32 v79, v79, v31
    v_cvt_pk_bf16_f32 v88, v72, v73
    v_cvt_pk_bf16_f32 v89, v74, v75
    v_cvt_pk_bf16_f32 v90, v76, v77
    v_cvt_pk_bf16_f32 v91, v78, v79
    buffer_store_dwordx4 v[88:91], v116, s[36:39], s48 offen offset:0 sc0 sc1
    v_mul_f32 v80, v32, v32
    v_mul_f32 v81, v33, v33
    v_mul_f32 v82, v34, v34
    v_mul_f32 v83, v35, v35
    v_mul_f32 v84, v36, v36
    v_mul_f32 v85, v37, v37
    v_mul_f32 v86, v38, v38
    v_mul_f32 v87, v39, v39
    v_fma_f32 v80, v80, v111, v110
    v_fma_f32 v81, v81, v111, v110
    v_fma_f32 v82, v82, v111, v110
    v_fma_f32 v83, v83, v111, v110
    v_fma_f32 v84, v84, v111, v110
    v_fma_f32 v85, v85, v111, v110
    v_fma_f32 v86, v86, v111, v110
    v_fma_f32 v87, v87, v111, v110
    v_mul_f32 v80, v80, v32
    v_mul_f32 v81, v81, v33
    v_mul_f32 v82, v82, v34
    v_mul_f32 v83, v83, v35
    v_mul_f32 v84, v84, v36
    v_mul_f32 v85, v85, v37
    v_mul_f32 v86, v86, v38
    v_mul_f32 v87, v87, v39
    v_exp_f32 v80, v80
    v_exp_f32 v81, v81
    v_exp_f32 v82, v82
    v_exp_f32 v83, v83
    v_exp_f32 v84, v84
    v_exp_f32 v85, v85
    v_exp_f32 v86, v86
    v_exp_f32 v87, v87
    v_add_f32 v80, 1.0, v80
    v_add_f32 v81, 1.0, v81
    v_add_f32 v82, 1.0, v82
    v_add_f32 v83, 1.0, v83
    v_add_f32 v84, 1.0, v84
    v_add_f32 v85, 1.0, v85
    v_add_f32 v86, 1.0, v86
    v_add_f32 v87, 1.0, v87
    v_rcp_f32 v80, v80
    v_rcp_f32 v81, v81
    v_rcp_f32 v82, v82
    v_rcp_f32 v83, v83
    v_rcp_f32 v84, v84
    v_rcp_f32 v85, v85
    v_rcp_f32 v86, v86
    v_rcp_f32 v87, v87
    v_mul_f32 v80, v80, v32
    v_mul_f32 v81, v81, v33
    v_mul_f32 v82, v82, v34
    v_mul_f32 v83, v83, v35
    v_mul_f32 v84, v84, v36
    v_mul_f32 v85, v85, v37
    v_mul_f32 v86, v86, v38
    v_mul_f32 v87, v87, v39
    v_cvt_pk_bf16_f32 v92, v80, v81
    v_cvt_pk_bf16_f32 v93, v82, v83
    v_cvt_pk_bf16_f32 v94, v84, v85
    v_cvt_pk_bf16_f32 v95, v86, v87
    buffer_store_dwordx4 v[92:95], v116, s[36:39], s49 offen offset:0 sc0 sc1
    v_mul_f32 v72, v40, v40
    v_mul_f32 v73, v41, v41
    v_mul_f32 v74, v42, v42
    v_mul_f32 v75, v43, v43
    v_mul_f32 v76, v44, v44
    v_mul_f32 v77, v45, v45
    v_mul_f32 v78, v46, v46
    v_mul_f32 v79, v47, v47
    v_fma_f32 v72, v72, v111, v110
    v_fma_f32 v73, v73, v111, v110
    v_fma_f32 v74, v74, v111, v110
    v_fma_f32 v75, v75, v111, v110
    v_fma_f32 v76, v76, v111, v110
    v_fma_f32 v77, v77, v111, v110
    v_fma_f32 v78, v78, v111, v110
    v_fma_f32 v79, v79, v111, v110
    v_mul_f32 v72, v72, v40
    v_mul_f32 v73, v73, v41
    v_mul_f32 v74, v74, v42
    v_mul_f32 v75, v75, v43
    v_mul_f32 v76, v76, v44
    v_mul_f32 v77, v77, v45
    v_mul_f32 v78, v78, v46
    v_mul_f32 v79, v79, v47
    v_exp_f32 v72, v72
    v_exp_f32 v73, v73
    v_exp_f32 v74, v74
    v_exp_f32 v75, v75
    v_exp_f32 v76, v76
    v_exp_f32 v77, v77
    v_exp_f32 v78, v78
    v_exp_f32 v79, v79
    v_add_f32 v72, 1.0, v72
    v_add_f32 v73, 1.0, v73
    v_add_f32 v74, 1.0, v74
    v_add_f32 v75, 1.0, v75
    v_add_f32 v76, 1.0, v76
    v_add_f32 v77, 1.0, v77
    v_add_f32 v78, 1.0, v78
    v_add_f32 v79, 1.0, v79
    v_rcp_f32 v72, v72
    v_rcp_f32 v73, v73
    v_rcp_f32 v74, v74
    v_rcp_f32 v75, v75
    v_rcp_f32 v76, v76
    v_rcp_f32 v77, v77
    v_rcp_f32 v78, v78
    v_rcp_f32 v79, v79
    v_mul_f32 v72, v72, v40
    v_mul_f32 v73, v73, v41
    v_mul_f32 v74, v74, v42
    v_mul_f32 v75, v75, v43
    v_mul_f32 v76, v76, v44
    v_mul_f32 v77, v77, v45
    v_mul_f32 v78, v78, v46
    v_mul_f32 v79, v79, v47
    v_cvt_pk_bf16_f32 v88, v72, v73
    v_cvt_pk_bf16_f32 v89, v74, v75
    v_cvt_pk_bf16_f32 v90, v76, v77
    v_cvt_pk_bf16_f32 v91, v78, v79
    buffer_store_dwordx4 v[88:91], v116, s[36:39], s46 offen offset:1024 sc0 sc1
    v_mul_f32 v80, v48, v48
    v_mul_f32 v81, v49, v49
    v_mul_f32 v82, v50, v50
    v_mul_f32 v83, v51, v51
    v_mul_f32 v84, v52, v52
    v_mul_f32 v85, v53, v53
    v_mul_f32 v86, v54, v54
    v_mul_f32 v87, v55, v55
    v_fma_f32 v80, v80, v111, v110
    v_fma_f32 v81, v81, v111, v110
    v_fma_f32 v82, v82, v111, v110
    v_fma_f32 v83, v83, v111, v110
    v_fma_f32 v84, v84, v111, v110
    v_fma_f32 v85, v85, v111, v110
    v_fma_f32 v86, v86, v111, v110
    v_fma_f32 v87, v87, v111, v110
    v_mul_f32 v80, v80, v48
    v_mul_f32 v81, v81, v49
    v_mul_f32 v82, v82, v50
    v_mul_f32 v83, v83, v51
    v_mul_f32 v84, v84, v52
    v_mul_f32 v85, v85, v53
    v_mul_f32 v86, v86, v54
    v_mul_f32 v87, v87, v55
    v_exp_f32 v80, v80
    v_exp_f32 v81, v81
    v_exp_f32 v82, v82
    v_exp_f32 v83, v83
    v_exp_f32 v84, v84
    v_exp_f32 v85, v85
    v_exp_f32 v86, v86
    v_exp_f32 v87, v87
    v_add_f32 v80, 1.0, v80
    v_add_f32 v81, 1.0, v81
    v_add_f32 v82, 1.0, v82
    v_add_f32 v83, 1.0, v83
    v_add_f32 v84, 1.0, v84
    v_add_f32 v85, 1.0, v85
    v_add_f32 v86, 1.0, v86
    v_add_f32 v87, 1.0, v87
    v_rcp_f32 v80, v80
    v_rcp_f32 v81, v81
    v_rcp_f32 v82, v82
    v_rcp_f32 v83, v83
    v_rcp_f32 v84, v84
    v_rcp_f32 v85, v85
    v_rcp_f32 v86, v86
    v_rcp_f32 v87, v87
    v_mul_f32 v80, v80, v48
    v_mul_f32 v81, v81, v49
    v_mul_f32 v82, v82, v50
    v_mul_f32 v83, v83, v51
    v_mul_f32 v84, v84, v52
    v_mul_f32 v85, v85, v53
    v_mul_f32 v86, v86, v54
    v_mul_f32 v87, v87, v55
    v_cvt_pk_bf16_f32 v92, v80, v81
    v_cvt_pk_bf16_f32 v93, v82, v83
    v_cvt_pk_bf16_f32 v94, v84, v85
    v_cvt_pk_bf16_f32 v95, v86, v87
    buffer_store_dwordx4 v[92:95], v116, s[36:39], s47 offen offset:1024 sc0 sc1
    v_mul_f32 v72, v56, v56
    v_mul_f32 v73, v57, v57
    v_mul_f32 v74, v58, v58
    v_mul_f32 v75, v59, v59
    v_mul_f32 v76, v60, v60
    v_mul_f32 v77, v61, v61
    v_mul_f32 v78, v62, v62
    v_mul_f32 v79, v63, v63
    v_fma_f32 v72, v72, v111, v110
    v_fma_f32 v73, v73, v111, v110
    v_fma_f32 v74, v74, v111, v110
    v_fma_f32 v75, v75, v111, v110
    v_fma_f32 v76, v76, v111, v110
    v_fma_f32 v77, v77, v111, v110
    v_fma_f32 v78, v78, v111, v110
    v_fma_f32 v79, v79, v111, v110
    v_mul_f32 v72, v72, v56
    v_mul_f32 v73, v73, v57
    v_mul_f32 v74, v74, v58
    v_mul_f32 v75, v75, v59
    v_mul_f32 v76, v76, v60
    v_mul_f32 v77, v77, v61
    v_mul_f32 v78, v78, v62
    v_mul_f32 v79, v79, v63
    v_exp_f32 v72, v72
    v_exp_f32 v73, v73
    v_exp_f32 v74, v74
    v_exp_f32 v75, v75
    v_exp_f32 v76, v76
    v_exp_f32 v77, v77
    v_exp_f32 v78, v78
    v_exp_f32 v79, v79
    v_add_f32 v72, 1.0, v72
    v_add_f32 v73, 1.0, v73
    v_add_f32 v74, 1.0, v74
    v_add_f32 v75, 1.0, v75
    v_add_f32 v76, 1.0, v76
    v_add_f32 v77, 1.0, v77
    v_add_f32 v78, 1.0, v78
    v_add_f32 v79, 1.0, v79
    v_rcp_f32 v72, v72
    v_rcp_f32 v73, v73
    v_rcp_f32 v74, v74
    v_rcp_f32 v75, v75
    v_rcp_f32 v76, v76
    v_rcp_f32 v77, v77
    v_rcp_f32 v78, v78
    v_rcp_f32 v79, v79
    v_mul_f32 v72, v72, v56
    v_mul_f32 v73, v73, v57
    v_mul_f32 v74, v74, v58
    v_mul_f32 v75, v75, v59
    v_mul_f32 v76, v76, v60
    v_mul_f32 v77, v77, v61
    v_mul_f32 v78, v78, v62
    v_mul_f32 v79, v79, v63
    v_cvt_pk_bf16_f32 v88, v72, v73
    v_cvt_pk_bf16_f32 v89, v74, v75
    v_cvt_pk_bf16_f32 v90, v76, v77
    v_cvt_pk_bf16_f32 v91, v78, v79
    buffer_store_dwordx4 v[88:91], v116, s[36:39], s48 offen offset:1024 sc0 sc1
    v_mul_f32 v80, v64, v64
    v_mul_f32 v81, v65, v65
    v_mul_f32 v82, v66, v66
    v_mul_f32 v83, v67, v67
    v_mul_f32 v84, v68, v68
    v_mul_f32 v85, v69, v69
    v_mul_f32 v86, v70, v70
    v_mul_f32 v87, v71, v71
    v_fma_f32 v80, v80, v111, v110
    v_fma_f32 v81, v81, v111, v110
    v_fma_f32 v82, v82, v111, v110
    v_fma_f32 v83, v83, v111, v110
    v_fma_f32 v84, v84, v111, v110
    v_fma_f32 v85, v85, v111, v110
    v_fma_f32 v86, v86, v111, v110
    v_fma_f32 v87, v87, v111, v110
    v_mul_f32 v80, v80, v64
    v_mul_f32 v81, v81, v65
    v_mul_f32 v82, v82, v66
    v_mul_f32 v83, v83, v67
    v_mul_f32 v84, v84, v68
    v_mul_f32 v85, v85, v69
    v_mul_f32 v86, v86, v70
    v_mul_f32 v87, v87, v71
    v_exp_f32 v80, v80
    v_exp_f32 v81, v81
    v_exp_f32 v82, v82
    v_exp_f32 v83, v83
    v_exp_f32 v84, v84
    v_exp_f32 v85, v85
    v_exp_f32 v86, v86
    v_exp_f32 v87, v87
    v_add_f32 v80, 1.0, v80
    v_add_f32 v81, 1.0, v81
    v_add_f32 v82, 1.0, v82
    v_add_f32 v83, 1.0, v83
    v_add_f32 v84, 1.0, v84
    v_add_f32 v85, 1.0, v85
    v_add_f32 v86, 1.0, v86
    v_add_f32 v87, 1.0, v87
    v_rcp_f32 v80, v80
    v_rcp_f32 v81, v81
    v_rcp_f32 v82, v82
    v_rcp_f32 v83, v83
    v_rcp_f32 v84, v84
    v_rcp_f32 v85, v85
    v_rcp_f32 v86, v86
    v_rcp_f32 v87, v87
    v_mul_f32 v80, v80, v64
    v_mul_f32 v81, v81, v65
    v_mul_f32 v82, v82, v66
    v_mul_f32 v83, v83, v67
    v_mul_f32 v84, v84, v68
    v_mul_f32 v85, v85, v69
    v_mul_f32 v86, v86, v70
    v_mul_f32 v87, v87, v71
    v_cvt_pk_bf16_f32 v92, v80, v81
    v_cvt_pk_bf16_f32 v93, v82, v83
    v_cvt_pk_bf16_f32 v94, v84, v85
    v_cvt_pk_bf16_f32 v95, v86, v87
    buffer_store_dwordx4 v[92:95], v116, s[36:39], s49 offen offset:1024 sc0 sc1
    s_branch k1_end
k1_qkv:
    s_cmp_ge_u32 s25, 10
    s_cbranch_scc1 k1_v
    v_add_u32 v110, s40, v104
    v_add_u32 v111, s40, v105
    v_add_u32 v112, s40, v106
    v_add_u32 v113, s40, v107
    v_add_u32 v114, s40, v108
    v_add_u32 v115, s40, v109
    s_mov_b32 s41, 10
    s_barrier
    ds_read_b128 v[72:75], v110 offset:0
    ds_read_b64_tr_b16 v[80:81], v114 offset:0
    ds_read_b64_tr_b16 v[82:83], v114 offset:1024
    ds_read_b64_tr_b16 v[84:85], v115 offset:0
    ds_read_b64_tr_b16 v[86:87], v115 offset:1024
    ds_read_b128 v[76:79], v110 offset:4096
k1_qk_loop:
    s_waitcnt lgkmcnt(3)
    v_mfma_f32_32x32x16_bf16 v[8:23], v[80:83], v[72:75], v[8:23]
    ds_read_b128 v[88:91], v111 offset:0
    ds_read_b64_tr_b16 v[96:97], v114 offset:4096
    ds_read_b64_tr_b16 v[98:99], v114 offset:5120
    s_waitcnt lgkmcnt(4)
    v_mfma_f32_32x32x16_bf16 v[24:39], v[84:87], v[72:75], v[24:39]
    ds_read_b64_tr_b16 v[100:101], v115 offset:4096
    ds_read_b64_tr_b16 v[102:103], v115 offset:5120
    ds_read_b128 v[92:95], v111 offset:4096
    s_waitcnt lgkmcnt(6)
    v_mfma_f32_32x32x16_bf16 v[40:55], v[80:83], v[76:79], v[40:55]
    v_mfma_f32_32x32x16_bf16 v[56:71], v[84:87], v[76:79], v[56:71]
    s_waitcnt lgkmcnt(3)
    v_mfma_f32_32x32x16_bf16 v[8:23], v[96:99], v[88:91], v[8:23]
    ds_read_b128 v[72:75], v112 offset:0
    ds_read_b64_tr_b16 v[80:81], v114 offset:8192
    ds_read_b64_tr_b16 v[82:83], v114 offset:9216
    s_waitcnt lgkmcnt(4)
    v_mfma_f32_32x32x16_bf16 v[24:39], v[100:103], v[88:91], v[24:39]
    ds_read_b64_tr_b16 v[84:85], v115 offset:8192
    ds_read_b64_tr_b16 v[86:87], v115 offset:9216
    ds_read_b128 v[76:79], v112 offset:4096
    s_waitcnt lgkmcnt(6)
    v_mfma_f32_32x32x16_bf16 v[40:55], v[96:99], v[92:95], v[40:55]
    v_mfma_f32_32x32x16_bf16 v[56:71], v[100:103], v[92:95], v[56:71]
    s_waitcnt lgkmcnt(3)
    v_mfma_f32_32x32x16_bf16 v[8:23], v[80:83], v[72:75], v[8:23]
    ds_read_b128 v[88:91], v113 offset:0
    ds_read_b64_tr_b16 v[96:97], v114 offset:12288
    ds_read_b64_tr_b16 v[98:99], v114 offset:13312
    s_waitcnt lgkmcnt(4)
    v_mfma_f32_32x32x16_bf16 v[24:39], v[84:87], v[72:75], v[24:39]
    ds_read_b64_tr_b16 v[100:101], v115 offset:12288
    ds_read_b64_tr_b16 v[102:103], v115 offset:13312
    ds_read_b128 v[92:95], v113 offset:4096
    s_waitcnt lgkmcnt(6)
    v_mfma_f32_32x32x16_bf16 v[40:55], v[80:83], v[76:79], v[40:55]
    v_mfma_f32_32x32x16_bf16 v[56:71], v[84:87], v[76:79], v[56:71]
    s_add_u32 s40, s40, 49152
    s_cmp_eq_u32 s40, 147456
    s_cselect_b32 s40, 0, s40
    s_waitcnt lgkmcnt(0)
    s_barrier
    v_mfma_f32_32x32x16_bf16 v[8:23], v[96:99], v[88:91], v[8:23]
    v_add_u32 v110, s40, v104
    v_add_u32 v111, s40, v105
    v_add_u32 v112, s40, v106
    v_add_u32 v113, s40, v107
    v_add_u32 v114, s40, v108
    v_add_u32 v115, s40, v109
    ds_read_b128 v[72:75], v110 offset:0
    ds_read_b64_tr_b16 v[80:81], v114 offset:0
    ds_read_b64_tr_b16 v[82:83], v114 offset:1024
    v_mfma_f32_32x32x16_bf16 v[24:39], v[100:103], v[88:91], v[24:39]
    ds_read_b64_tr_b16 v[84:85], v115 offset:0
    ds_read_b64_tr_b16 v[86:87], v115 offset:1024
    ds_read_b128 v[76:79], v110 offset:4096
    v_mfma_f32_32x32x16_bf16 v[40:55], v[96:99], v[92:95], v[40:55]
    v_mfma_f32_32x32x16_bf16 v[56:71], v[100:103], v[92:95], v[56:71]
    s_sub_u32 s41, s41, 1
    s_cmp_lg_u32 s41, 0
    s_cbranch_scc1 k1_qk_loop
    s_waitcnt lgkmcnt(0)
    s_mov_b32 s44, 2
    s_nop 15
    s_branch k1_sync
k1_ret_qk:
    s_cmp_lt_u32 s25, 5
    s_cselect_b32 s51, 0x3ea52b5c, 1.0
    v_and_b32 v108, 31, v0
    s_lshl_b32 s46, s42, 8
    v_lshlrev_b32 v108, 2, v108
    v_add_u32 v108, s46, v108
    v_add_u32 v108, 147456, v108
    ds_read_b32 v104, v108
    ds_read_b32 v105, v108 offset:128
    ds_read_b32 v106, v108 offset:1024
    ds_read_b32 v107, v108 offset:1152
    v_lshrrev_b32 v109, 5, v0
    v_lshlrev_b32 v109, 4, v109
    s_lshl_b32 s46, s43, 8
    v_add_u32 v109, s46, v109
    v_add_u32 v109, 149504, v109
    ds_read_b128 v[72:75], v109 offset:0
    ds_read_b128 v[76:79], v109 offset:32
    ds_read_b128 v[80:83], v109 offset:64
    ds_read_b128 v[84:87], v109 offset:96
    ds_read_b128 v[88:91], v109 offset:128
    ds_read_b128 v[92:95], v109 offset:160
    ds_read_b128 v[96:99], v109 offset:192
    ds_read_b128 v[100:103], v109 offset:224
    s_waitcnt lgkmcnt(4)
    v_mul_f32 v106, s51, v106
    v_mul_f32 v107, s51, v107
    v_fma_f32 v8, -v104, v72, v8
    v_fma_f32 v9, -v104, v73, v9
    v_fma_f32 v10, -v104, v74, v10
    v_fma_f32 v11, -v104, v75, v11
    v_fma_f32 v12, -v104, v76, v12
    v_fma_f32 v13, -v104, v77, v13
    v_fma_f32 v14, -v104, v78, v14
    v_fma_f32 v15, -v104, v79, v15
    v_fma_f32 v16, -v104, v80, v16
    v_fma_f32 v17, -v104, v81, v17
    v_fma_f32 v18, -v104, v82, v18
    v_fma_f32 v19, -v104, v83, v19
    v_fma_f32 v20, -v104, v84, v20
    v_fma_f32 v21, -v104, v85, v21
    v_fma_f32 v22, -v104, v86, v22
    v_fma_f32 v23, -v104, v87, v23
    v_fma_f32 v40, -v105, v72, v40
    v_fma_f32 v41, -v105, v73, v41
    v_fma_f32 v42, -v105, v74, v42
    v_fma_f32 v43, -v105, v75, v43
    v_fma_f32 v44, -v105, v76, v44
    v_fma_f32 v45, -v105, v77, v45
    v_fma_f32 v46, -v105, v78, v46
    v_fma_f32 v47, -v105, v79, v47
    v_fma_f32 v48, -v105, v80, v48
    v_fma_f32 v49, -v105, v81, v49
    v_fma_f32 v50, -v105, v82, v50
    v_fma_f32 v51, -v105, v83, v51
    v_fma_f32 v52, -v105, v84, v52
    v_fma_f32 v53, -v105, v85, v53
    v_fma_f32 v54, -v105, v86, v54
    v_fma_f32 v55, -v105, v87, v55
    s_waitcnt lgkmcnt(0)
    v_fma_f32 v24, -v104, v88, v24
    v_fma_f32 v25, -v104, v89, v25
    v_fma_f32 v26, -v104, v90, v26
    v_fma_f32 v27, -v104, v91, v27
    v_fma_f32 v28, -v104, v92, v28
    v_fma_f32 v29, -v104, v93, v29
    v_fma_f32 v30, -v104, v94, v30
    v_fma_f32 v31, -v104, v95, v31
    v_fma_f32 v32, -v104, v96, v32
    v_fma_f32 v33, -v104, v97, v33
    v_fma_f32 v34, -v104, v98, v34
    v_fma_f32 v35, -v104, v99, v35
    v_fma_f32 v36, -v104, v100, v36
    v_fma_f32 v37, -v104, v101, v37
    v_fma_f32 v38, -v104, v102, v38
    v_fma_f32 v39, -v104, v103, v39
    v_fma_f32 v56, -v105, v88, v56
    v_fma_f32 v57, -v105, v89, v57
    v_fma_f32 v58, -v105, v90, v58
    v_fma_f32 v59, -v105, v91, v59
    v_fma_f32 v60, -v105, v92, v60
    v_fma_f32 v61, -v105, v93, v61
    v_fma_f32 v62, -v105, v94, v62
    v_fma_f32 v63, -v105, v95, v63
    v_fma_f32 v64, -v105, v96, v64
    v_fma_f32 v65, -v105, v97, v65
    v_fma_f32 v66, -v105, v98, v66
    v_fma_f32 v67, -v105, v99, v67
    v_fma_f32 v68, -v105, v100, v68
    v_fma_f32 v69, -v105, v101, v69
    v_fma_f32 v70, -v105, v102, v70
    v_fma_f32 v71, -v105, v103, v71
    s_cmp_lt_u32 s25, 5
    s_mov_b32 s47, 2560
    s_cselect_b32 s47, 1280, s47
    s_mov_b32 s52, 7864320
    s_cselect_b32 s52, 5242880, s52
    s_cselect_b32 s53, 0, 5
    s_sub_u32 s53, s25, s53
    s_lshl_b32 s53, s53, 5
    s_lshl_b32 s48, s43, 4
    s_add_u32 s53, s53, s48
    s_lshl_b32 s48, s23, 3
    s_lshl_b32 s49, s42, 1
    s_add_u32 s48, s48, s49
    s_mul_i32 s48, s48, s47
    s_add_u32 s48, s48, s52
    s_add_u32 s49, s48, s47
    s_lshl_b32 s50, s47, 6
    v_lshrrev_b32 v72, 5, v0
    v_add_u32 v72, s53, v72
    v_and_b32 v73, 31, v0
    v_lshlrev_b32 v74, 4, v73
    v_lshlrev_b32 v75, 3, v73
    v_add_u32 v76, 0, v72
    v_mul_u32_u24 v77, 205, v76
    v_lshrrev_b32 v77, 10, v77
    v_mul_u32_u24 v78, 5, v77
    v_sub_u32 v78, v76, v78
    v_cmp_eq_u32 vcc, 4, v78
    v_mul_lo_u32 v79, v77, s50
    v_lshrrev_b32 v76, 1, v78
    v_lshl_add_u32 v79, v76, 9, v79
    v_and_b32 v76, 1, v78
    v_lshl_add_u32 v79, v76, 3, v79
    v_cndmask_b32 v76, v74, v75, vcc
    v_add_u32 v79, v79, v76
    v_mul_f32 v8, v8, v106
    v_mul_f32 v9, v9, v106
    v_mul_f32 v10, v10, v106
    v_mul_f32 v11, v11, v106
    v_cvt_pk_bf16_f32 v80, v8, v9
    v_cvt_pk_bf16_f32 v81, v10, v11
    buffer_store_dwordx2 v[80:81], v79, s[36:39], s48 offen
    v_mul_f32 v40, v40, v107
    v_mul_f32 v41, v41, v107
    v_mul_f32 v42, v42, v107
    v_mul_f32 v43, v43, v107
    v_cvt_pk_bf16_f32 v82, v40, v41
    v_cvt_pk_bf16_f32 v83, v42, v43
    buffer_store_dwordx2 v[82:83], v79, s[36:39], s49 offen
    v_add_u32 v76, 2, v72
    v_mul_u32_u24 v77, 205, v76
    v_lshrrev_b32 v77, 10, v77
    v_mul_u32_u24 v78, 5, v77
    v_sub_u32 v78, v76, v78
    v_cmp_eq_u32 vcc, 4, v78
    v_mul_lo_u32 v79, v77, s50
    v_lshrrev_b32 v76, 1, v78
    v_lshl_add_u32 v79, v76, 9, v79
    v_and_b32 v76, 1, v78
    v_lshl_add_u32 v79, v76, 3, v79
    v_cndmask_b32 v76, v74, v75, vcc
    v_add_u32 v79, v79, v76
    v_mul_f32 v12, v12, v106
    v_mul_f32 v13, v13, v106
    v_mul_f32 v14, v14, v106
    v_mul_f32 v15, v15, v106
    v_cvt_pk_bf16_f32 v80, v12, v13
    v_cvt_pk_bf16_f32 v81, v14, v15
    buffer_store_dwordx2 v[80:81], v79, s[36:39], s48 offen
    v_mul_f32 v44, v44, v107
    v_mul_f32 v45, v45, v107
    v_mul_f32 v46, v46, v107
    v_mul_f32 v47, v47, v107
    v_cvt_pk_bf16_f32 v82, v44, v45
    v_cvt_pk_bf16_f32 v83, v46, v47
    buffer_store_dwordx2 v[82:83], v79, s[36:39], s49 offen
    v_add_u32 v76, 4, v72
    v_mul_u32_u24 v77, 205, v76
    v_lshrrev_b32 v77, 10, v77
    v_mul_u32_u24 v78, 5, v77
    v_sub_u32 v78, v76, v78
    v_cmp_eq_u32 vcc, 4, v78
    v_mul_lo_u32 v79, v77, s50
    v_lshrrev_b32 v76, 1, v78
    v_lshl_add_u32 v79, v76, 9, v79
    v_and_b32 v76, 1, v78
    v_lshl_add_u32 v79, v76, 3, v79
    v_cndmask_b32 v76, v74, v75, vcc
    v_add_u32 v79, v79, v76
    v_mul_f32 v16, v16, v106
    v_mul_f32 v17, v17, v106
    v_mul_f32 v18, v18, v106
    v_mul_f32 v19, v19, v106
    v_cvt_pk_bf16_f32 v80, v16, v17
    v_cvt_pk_bf16_f32 v81, v18, v19
    buffer_store_dwordx2 v[80:81], v79, s[36:39], s48 offen
    v_mul_f32 v48, v48, v107
    v_mul_f32 v49, v49, v107
    v_mul_f32 v50, v50, v107
    v_mul_f32 v51, v51, v107
    v_cvt_pk_bf16_f32 v82, v48, v49
    v_cvt_pk_bf16_f32 v83, v50, v51
    buffer_store_dwordx2 v[82:83], v79, s[36:39], s49 offen
    v_add_u32 v76, 6, v72
    v_mul_u32_u24 v77, 205, v76
    v_lshrrev_b32 v77, 10, v77
    v_mul_u32_u24 v78, 5, v77
    v_sub_u32 v78, v76, v78
    v_cmp_eq_u32 vcc, 4, v78
    v_mul_lo_u32 v79, v77, s50
    v_lshrrev_b32 v76, 1, v78
    v_lshl_add_u32 v79, v76, 9, v79
    v_and_b32 v76, 1, v78
    v_lshl_add_u32 v79, v76, 3, v79
    v_cndmask_b32 v76, v74, v75, vcc
    v_add_u32 v79, v79, v76
    v_mul_f32 v20, v20, v106
    v_mul_f32 v21, v21, v106
    v_mul_f32 v22, v22, v106
    v_mul_f32 v23, v23, v106
    v_cvt_pk_bf16_f32 v80, v20, v21
    v_cvt_pk_bf16_f32 v81, v22, v23
    buffer_store_dwordx2 v[80:81], v79, s[36:39], s48 offen
    v_mul_f32 v52, v52, v107
    v_mul_f32 v53, v53, v107
    v_mul_f32 v54, v54, v107
    v_mul_f32 v55, v55, v107
    v_cvt_pk_bf16_f32 v82, v52, v53
    v_cvt_pk_bf16_f32 v83, v54, v55
    buffer_store_dwordx2 v[82:83], v79, s[36:39], s49 offen
    v_add_u32 v76, 8, v72
    v_mul_u32_u24 v77, 205, v76
    v_lshrrev_b32 v77, 10, v77
    v_mul_u32_u24 v78, 5, v77
    v_sub_u32 v78, v76, v78
    v_cmp_eq_u32 vcc, 4, v78
    v_mul_lo_u32 v79, v77, s50
    v_lshrrev_b32 v76, 1, v78
    v_lshl_add_u32 v79, v76, 9, v79
    v_and_b32 v76, 1, v78
    v_lshl_add_u32 v79, v76, 3, v79
    v_cndmask_b32 v76, v74, v75, vcc
    v_add_u32 v79, v79, v76
    v_mul_f32 v24, v24, v106
    v_mul_f32 v25, v25, v106
    v_mul_f32 v26, v26, v106
    v_mul_f32 v27, v27, v106
    v_cvt_pk_bf16_f32 v80, v24, v25
    v_cvt_pk_bf16_f32 v81, v26, v27
    buffer_store_dwordx2 v[80:81], v79, s[36:39], s48 offen
    v_mul_f32 v56, v56, v107
    v_mul_f32 v57, v57, v107
    v_mul_f32 v58, v58, v107
    v_mul_f32 v59, v59, v107
    v_cvt_pk_bf16_f32 v82, v56, v57
    v_cvt_pk_bf16_f32 v83, v58, v59
    buffer_store_dwordx2 v[82:83], v79, s[36:39], s49 offen
    v_add_u32 v76, 10, v72
    v_mul_u32_u24 v77, 205, v76
    v_lshrrev_b32 v77, 10, v77
    v_mul_u32_u24 v78, 5, v77
    v_sub_u32 v78, v76, v78
    v_cmp_eq_u32 vcc, 4, v78
    v_mul_lo_u32 v79, v77, s50
    v_lshrrev_b32 v76, 1, v78
    v_lshl_add_u32 v79, v76, 9, v79
    v_and_b32 v76, 1, v78
    v_lshl_add_u32 v79, v76, 3, v79
    v_cndmask_b32 v76, v74, v75, vcc
    v_add_u32 v79, v79, v76
    v_mul_f32 v28, v28, v106
    v_mul_f32 v29, v29, v106
    v_mul_f32 v30, v30, v106
    v_mul_f32 v31, v31, v106
    v_cvt_pk_bf16_f32 v80, v28, v29
    v_cvt_pk_bf16_f32 v81, v30, v31
    buffer_store_dwordx2 v[80:81], v79, s[36:39], s48 offen
    v_mul_f32 v60, v60, v107
    v_mul_f32 v61, v61, v107
    v_mul_f32 v62, v62, v107
    v_mul_f32 v63, v63, v107
    v_cvt_pk_bf16_f32 v82, v60, v61
    v_cvt_pk_bf16_f32 v83, v62, v63
    buffer_store_dwordx2 v[82:83], v79, s[36:39], s49 offen
    v_add_u32 v76, 12, v72
    v_mul_u32_u24 v77, 205, v76
    v_lshrrev_b32 v77, 10, v77
    v_mul_u32_u24 v78, 5, v77
    v_sub_u32 v78, v76, v78
    v_cmp_eq_u32 vcc, 4, v78
    v_mul_lo_u32 v79, v77, s50
    v_lshrrev_b32 v76, 1, v78
    v_lshl_add_u32 v79, v76, 9, v79
    v_and_b32 v76, 1, v78
    v_lshl_add_u32 v79, v76, 3, v79
    v_cndmask_b32 v76, v74, v75, vcc
    v_add_u32 v79, v79, v76
    v_mul_f32 v32, v32, v106
    v_mul_f32 v33, v33, v106
    v_mul_f32 v34, v34, v106
    v_mul_f32 v35, v35, v106
    v_cvt_pk_bf16_f32 v80, v32, v33
    v_cvt_pk_bf16_f32 v81, v34, v35
    buffer_store_dwordx2 v[80:81], v79, s[36:39], s48 offen
    v_mul_f32 v64, v64, v107
    v_mul_f32 v65, v65, v107
    v_mul_f32 v66, v66, v107
    v_mul_f32 v67, v67, v107
    v_cvt_pk_bf16_f32 v82, v64, v65
    v_cvt_pk_bf16_f32 v83, v66, v67
    buffer_store_dwordx2 v[82:83], v79, s[36:39], s49 offen
    v_add_u32 v76, 14, v72
    v_mul_u32_u24 v77, 205, v76
    v_lshrrev_b32 v77, 10, v77
    v_mul_u32_u24 v78, 5, v77
    v_sub_u32 v78, v76, v78
    v_cmp_eq_u32 vcc, 4, v78
    v_mul_lo_u32 v79, v77, s50
    v_lshrrev_b32 v76, 1, v78
    v_lshl_add_u32 v79, v76, 9, v79
    v_and_b32 v76, 1, v78
    v_lshl_add_u32 v79, v76, 3, v79
    v_cndmask_b32 v76, v74, v75, vcc
    v_add_u32 v79, v79, v76
    v_mul_f32 v36, v36, v106
    v_mul_f32 v37, v37, v106
    v_mul_f32 v38, v38, v106
    v_mul_f32 v39, v39, v106
    v_cvt_pk_bf16_f32 v80, v36, v37
    v_cvt_pk_bf16_f32 v81, v38, v39
    buffer_store_dwordx2 v[80:81], v79, s[36:39], s48 offen
    v_mul_f32 v68, v68, v107
    v_mul_f32 v69, v69, v107
    v_mul_f32 v70, v70, v107
    v_mul_f32 v71, v71, v107
    v_cvt_pk_bf16_f32 v82, v68, v69
    v_cvt_pk_bf16_f32 v83, v70, v71
    buffer_store_dwordx2 v[82:83], v79, s[36:39], s49 offen
    s_branch k1_end
k1_v:
    v_add_u32 v110, s40, v104
    v_add_u32 v111, s40, v105
    v_add_u32 v112, s40, v106
    v_add_u32 v113, s40, v107
    v_add_u32 v114, s40, v108
    v_add_u32 v115, s40, v109
    s_mov_b32 s41, 10
    s_barrier
    ds_read_b128 v[72:75], v110 offset:0
    ds_read_b64_tr_b16 v[80:81], v114 offset:0
    ds_read_b64_tr_b16 v[82:83], v114 offset:1024
    ds_read_b64_tr_b16 v[84:85], v115 offset:0
    ds_read_b64_tr_b16 v[86:87], v115 offset:1024
    ds_read_b128 v[76:79], v110 offset:4096
k1_v_loop:
    s_waitcnt lgkmcnt(3)
    v_mfma_f32_32x32x16_bf16 v[8:23], v[72:75], v[80:83], v[8:23]
    ds_read_b128 v[88:91], v111 offset:0
    ds_read_b64_tr_b16 v[96:97], v114 offset:4096
    ds_read_b64_tr_b16 v[98:99], v114 offset:5120
    s_waitcnt lgkmcnt(4)
    v_mfma_f32_32x32x16_bf16 v[24:39], v[72:75], v[84:87], v[24:39]
    ds_read_b64_tr_b16 v[100:101], v115 offset:4096
    ds_read_b64_tr_b16 v[102:103], v115 offset:5120
    ds_read_b128 v[92:95], v111 offset:4096
    s_waitcnt lgkmcnt(6)
    v_mfma_f32_32x32x16_bf16 v[40:55], v[76:79], v[80:83], v[40:55]
    v_mfma_f32_32x32x16_bf16 v[56:71], v[76:79], v[84:87], v[56:71]
    s_waitcnt lgkmcnt(3)
    v_mfma_f32_32x32x16_bf16 v[8:23], v[88:91], v[96:99], v[8:23]
    ds_read_b128 v[72:75], v112 offset:0
    ds_read_b64_tr_b16 v[80:81], v114 offset:8192
    ds_read_b64_tr_b16 v[82:83], v114 offset:9216
    s_waitcnt lgkmcnt(4)
    v_mfma_f32_32x32x16_bf16 v[24:39], v[88:91], v[100:103], v[24:39]
    ds_read_b64_tr_b16 v[84:85], v115 offset:8192
    ds_read_b64_tr_b16 v[86:87], v115 offset:9216
    ds_read_b128 v[76:79], v112 offset:4096
    s_waitcnt lgkmcnt(6)
    v_mfma_f32_32x32x16_bf16 v[40:55], v[92:95], v[96:99], v[40:55]
    v_mfma_f32_32x32x16_bf16 v[56:71], v[92:95], v[100:103], v[56:71]
    s_waitcnt lgkmcnt(3)
    v_mfma_f32_32x32x16_bf16 v[8:23], v[72:75], v[80:83], v[8:23]
    ds_read_b128 v[88:91], v113 offset:0
    ds_read_b64_tr_b16 v[96:97], v114 offset:12288
    ds_read_b64_tr_b16 v[98:99], v114 offset:13312
    s_waitcnt lgkmcnt(4)
    v_mfma_f32_32x32x16_bf16 v[24:39], v[72:75], v[84:87], v[24:39]
    ds_read_b64_tr_b16 v[100:101], v115 offset:12288
    ds_read_b64_tr_b16 v[102:103], v115 offset:13312
    ds_read_b128 v[92:95], v113 offset:4096
    s_waitcnt lgkmcnt(6)
    v_mfma_f32_32x32x16_bf16 v[40:55], v[76:79], v[80:83], v[40:55]
    v_mfma_f32_32x32x16_bf16 v[56:71], v[76:79], v[84:87], v[56:71]
    s_add_u32 s40, s40, 49152
    s_cmp_eq_u32 s40, 147456
    s_cselect_b32 s40, 0, s40
    s_waitcnt lgkmcnt(0)
    s_barrier
    v_mfma_f32_32x32x16_bf16 v[8:23], v[88:91], v[96:99], v[8:23]
    v_add_u32 v110, s40, v104
    v_add_u32 v111, s40, v105
    v_add_u32 v112, s40, v106
    v_add_u32 v113, s40, v107
    v_add_u32 v114, s40, v108
    v_add_u32 v115, s40, v109
    ds_read_b128 v[72:75], v110 offset:0
    ds_read_b64_tr_b16 v[80:81], v114 offset:0
    ds_read_b64_tr_b16 v[82:83], v114 offset:1024
    v_mfma_f32_32x32x16_bf16 v[24:39], v[88:91], v[100:103], v[24:39]
    ds_read_b64_tr_b16 v[84:85], v115 offset:0
    ds_read_b64_tr_b16 v[86:87], v115 offset:1024
    ds_read_b128 v[76:79], v110 offset:4096
    v_mfma_f32_32x32x16_bf16 v[40:55], v[92:95], v[96:99], v[40:55]
    v_mfma_f32_32x32x16_bf16 v[56:71], v[92:95], v[100:103], v[56:71]
    s_sub_u32 s41, s41, 1
    s_cmp_lg_u32 s41, 0
    s_cbranch_scc1 k1_v_loop
    s_waitcnt lgkmcnt(0)
    s_mov_b32 s44, 3
    s_nop 15
    s_branch k1_sync
k1_ret_v:
    s_waitcnt vmcnt(0)
    v_and_b32 v108, 31, v0
    v_lshlrev_b32 v108, 2, v108
    s_lshl_b32 s46, s43, 8
    v_add_u32 v108, s46, v108
    v_add_u32 v108, 149504, v108
    ds_read_b32 v104, v108
    ds_read_b32 v105, v108 offset:128
    v_lshrrev_b32 v109, 5, v0
    v_lshlrev_b32 v109, 4, v109
    s_lshl_b32 s46, s42, 8
    v_add_u32 v109, s46, v109
    v_add_u32 v109, 147456, v109
    ds_read_b128 v[72:75], v109 offset:0
    ds_read_b128 v[88:91], v109 offset:1024
    ds_read_b128 v[76:79], v109 offset:32
    ds_read_b128 v[92:95], v109 offset:1056
    ds_read_b128 v[80:83], v109 offset:64
    ds_read_b128 v[96:99], v109 offset:1088
    ds_read_b128 v[84:87], v109 offset:96
    ds_read_b128 v[100:103], v109 offset:1120
    s_waitcnt lgkmcnt(0)
    v_fma_f32 v8, -v72, v104, v8
    v_fma_f32 v9, -v73, v104, v9
    v_fma_f32 v10, -v74, v104, v10
    v_fma_f32 v11, -v75, v104, v11
    v_fma_f32 v12, -v76, v104, v12
    v_fma_f32 v13, -v77, v104, v13
    v_fma_f32 v14, -v78, v104, v14
    v_fma_f32 v15, -v79, v104, v15
    v_fma_f32 v16, -v80, v104, v16
    v_fma_f32 v17, -v81, v104, v17
    v_fma_f32 v18, -v82, v104, v18
    v_fma_f32 v19, -v83, v104, v19
    v_fma_f32 v20, -v84, v104, v20
    v_fma_f32 v21, -v85, v104, v21
    v_fma_f32 v22, -v86, v104, v22
    v_fma_f32 v23, -v87, v104, v23
    v_mul_f32 v8, v8, v88
    v_mul_f32 v9, v9, v89
    v_mul_f32 v10, v10, v90
    v_mul_f32 v11, v11, v91
    v_mul_f32 v12, v12, v92
    v_mul_f32 v13, v13, v93
    v_mul_f32 v14, v14, v94
    v_mul_f32 v15, v15, v95
    v_mul_f32 v16, v16, v96
    v_mul_f32 v17, v17, v97
    v_mul_f32 v18, v18, v98
    v_mul_f32 v19, v19, v99
    v_mul_f32 v20, v20, v100
    v_mul_f32 v21, v21, v101
    v_mul_f32 v22, v22, v102
    v_mul_f32 v23, v23, v103
    v_fma_f32 v24, -v72, v105, v24
    v_fma_f32 v25, -v73, v105, v25
    v_fma_f32 v26, -v74, v105, v26
    v_fma_f32 v27, -v75, v105, v27
    v_fma_f32 v28, -v76, v105, v28
    v_fma_f32 v29, -v77, v105, v29
    v_fma_f32 v30, -v78, v105, v30
    v_fma_f32 v31, -v79, v105, v31
    v_fma_f32 v32, -v80, v105, v32
    v_fma_f32 v33, -v81, v105, v33
    v_fma_f32 v34, -v82, v105, v34
    v_fma_f32 v35, -v83, v105, v35
    v_fma_f32 v36, -v84, v105, v36
    v_fma_f32 v37, -v85, v105, v37
    v_fma_f32 v38, -v86, v105, v38
    v_fma_f32 v39, -v87, v105, v39
    v_mul_f32 v24, v24, v88
    v_mul_f32 v25, v25, v89
    v_mul_f32 v26, v26, v90
    v_mul_f32 v27, v27, v91
    v_mul_f32 v28, v28, v92
    v_mul_f32 v29, v29, v93
    v_mul_f32 v30, v30, v94
    v_mul_f32 v31, v31, v95
    v_mul_f32 v32, v32, v96
    v_mul_f32 v33, v33, v97
    v_mul_f32 v34, v34, v98
    v_mul_f32 v35, v35, v99
    v_mul_f32 v36, v36, v100
    v_mul_f32 v37, v37, v101
    v_mul_f32 v38, v38, v102
    v_mul_f32 v39, v39, v103
    ds_read_b128 v[72:75], v109 offset:128
    ds_read_b128 v[88:91], v109 offset:1152
    ds_read_b128 v[76:79], v109 offset:160
    ds_read_b128 v[92:95], v109 offset:1184
    ds_read_b128 v[80:83], v109 offset:192
    ds_read_b128 v[96:99], v109 offset:1216
    ds_read_b128 v[84:87], v109 offset:224
    ds_read_b128 v[100:103], v109 offset:1248
    s_waitcnt lgkmcnt(0)
    v_fma_f32 v40, -v72, v104, v40
    v_fma_f32 v41, -v73, v104, v41
    v_fma_f32 v42, -v74, v104, v42
    v_fma_f32 v43, -v75, v104, v43
    v_fma_f32 v44, -v76, v104, v44
    v_fma_f32 v45, -v77, v104, v45
    v_fma_f32 v46, -v78, v104, v46
    v_fma_f32 v47, -v79, v104, v47
    v_fma_f32 v48, -v80, v104, v48
    v_fma_f32 v49, -v81, v104, v49
    v_fma_f32 v50, -v82, v104, v50
    v_fma_f32 v51, -v83, v104, v51
    v_fma_f32 v52, -v84, v104, v52
    v_fma_f32 v53, -v85, v104, v53
    v_fma_f32 v54, -v86, v104, v54
    v_fma_f32 v55, -v87, v104, v55
    v_mul_f32 v40, v40, v88
    v_mul_f32 v41, v41, v89
    v_mul_f32 v42, v42, v90
    v_mul_f32 v43, v43, v91
    v_mul_f32 v44, v44, v92
    v_mul_f32 v45, v45, v93
    v_mul_f32 v46, v46, v94
    v_mul_f32 v47, v47, v95
    v_mul_f32 v48, v48, v96
    v_mul_f32 v49, v49, v97
    v_mul_f32 v50, v50, v98
    v_mul_f32 v51, v51, v99
    v_mul_f32 v52, v52, v100
    v_mul_f32 v53, v53, v101
    v_mul_f32 v54, v54, v102
    v_mul_f32 v55, v55, v103
    v_fma_f32 v56, -v72, v105, v56
    v_fma_f32 v57, -v73, v105, v57
    v_fma_f32 v58, -v74, v105, v58
    v_fma_f32 v59, -v75, v105, v59
    v_fma_f32 v60, -v76, v105, v60
    v_fma_f32 v61, -v77, v105, v61
    v_fma_f32 v62, -v78, v105, v62
    v_fma_f32 v63, -v79, v105, v63
    v_fma_f32 v64, -v80, v105, v64
    v_fma_f32 v65, -v81, v105, v65
    v_fma_f32 v66, -v82, v105, v66
    v_fma_f32 v67, -v83, v105, v67
    v_fma_f32 v68, -v84, v105, v68
    v_fma_f32 v69, -v85, v105, v69
    v_fma_f32 v70, -v86, v105, v70
    v_fma_f32 v71, -v87, v105, v71
    v_mul_f32 v56, v56, v88
    v_mul_f32 v57, v57, v89
    v_mul_f32 v58, v58, v90
    v_mul_f32 v59, v59, v91
    v_mul_f32 v60, v60, v92
    v_mul_f32 v61, v61, v93
    v_mul_f32 v62, v62, v94
    v_mul_f32 v63, v63, v95
    v_mul_f32 v64, v64, v96
    v_mul_f32 v65, v65, v97
    v_mul_f32 v66, v66, v98
    v_mul_f32 v67, v67, v99
    v_mul_f32 v68, v68, v100
    v_mul_f32 v69, v69, v101
    v_mul_f32 v70, v70, v102
    v_mul_f32 v71, v71, v103
    s_sub_u32 s46, s25, 10
    s_lshl_b32 s46, s46, 7
    s_lshl_b32 s47, s43, 6
    s_add_u32 s46, s46, s47
    s_lshl_b32 s48, s23, 3
    s_lshl_b32 s49, s42, 1
    s_add_u32 s48, s48, s49
    s_mul_i32 s48, s48, 2560
    s_add_u32 s48, s48, 7865600
    s_mov_b32 s50, 163840
    v_and_b32 v72, 31, v0
    v_add_u32 v72, s46, v72
    v_lshrrev_b32 v73, 5, v0
    v_mul_u32_u24 v73, 320, v73
    v_add_u32 v76, 0, v72
    v_mul_u32_u24 v77, 3277, v76
    v_lshrrev_b32 v77, 16, v77
    v_mul_u32_u24 v78, 20, v77
    v_sub_u32 v78, v76, v78
    v_mul_lo_u32 v79, v77, s50
    v_lshl_add_u32 v79, v78, 4, v79
    v_add_u32 v79, v79, v73
    v_cvt_pk_bf16_f32 v80, v8, v9
    v_cvt_pk_bf16_f32 v81, v10, v11
    v_cvt_pk_bf16_f32 v82, v12, v13
    v_cvt_pk_bf16_f32 v83, v14, v15
    buffer_store_dwordx4 v[80:83], v79, s[36:39], s48 offen offset:0 sc0 sc1
    v_cvt_pk_bf16_f32 v84, v16, v17
    v_cvt_pk_bf16_f32 v85, v18, v19
    v_cvt_pk_bf16_f32 v86, v20, v21
    v_cvt_pk_bf16_f32 v87, v22, v23
    buffer_store_dwordx4 v[84:87], v79, s[36:39], s48 offen offset:640 sc0 sc1
    v_cvt_pk_bf16_f32 v80, v40, v41
    v_cvt_pk_bf16_f32 v81, v42, v43
    v_cvt_pk_bf16_f32 v82, v44, v45
    v_cvt_pk_bf16_f32 v83, v46, v47
    buffer_store_dwordx4 v[80:83], v79, s[36:39], s48 offen offset:2560 sc0 sc1
    v_cvt_pk_bf16_f32 v84, v48, v49
    v_cvt_pk_bf16_f32 v85, v50, v51
    v_cvt_pk_bf16_f32 v86, v52, v53
    v_cvt_pk_bf16_f32 v87, v54, v55
    buffer_store_dwordx4 v[84:87], v79, s[36:39], s48 offen offset:3200 sc0 sc1
    v_add_u32 v76, 32, v72
    v_mul_u32_u24 v77, 3277, v76
    v_lshrrev_b32 v77, 16, v77
    v_mul_u32_u24 v78, 20, v77
    v_sub_u32 v78, v76, v78
    v_mul_lo_u32 v79, v77, s50
    v_lshl_add_u32 v79, v78, 4, v79
    v_add_u32 v79, v79, v73
    v_cvt_pk_bf16_f32 v80, v24, v25
    v_cvt_pk_bf16_f32 v81, v26, v27
    v_cvt_pk_bf16_f32 v82, v28, v29
    v_cvt_pk_bf16_f32 v83, v30, v31
    buffer_store_dwordx4 v[80:83], v79, s[36:39], s48 offen offset:0 sc0 sc1
    v_cvt_pk_bf16_f32 v84, v32, v33
    v_cvt_pk_bf16_f32 v85, v34, v35
    v_cvt_pk_bf16_f32 v86, v36, v37
    v_cvt_pk_bf16_f32 v87, v38, v39
    buffer_store_dwordx4 v[84:87], v79, s[36:39], s48 offen offset:640 sc0 sc1
    v_cvt_pk_bf16_f32 v80, v56, v57
    v_cvt_pk_bf16_f32 v81, v58, v59
    v_cvt_pk_bf16_f32 v82, v60, v61
    v_cvt_pk_bf16_f32 v83, v62, v63
    buffer_store_dwordx4 v[80:83], v79, s[36:39], s48 offen offset:2560 sc0 sc1
    v_cvt_pk_bf16_f32 v84, v64, v65
    v_cvt_pk_bf16_f32 v85, v66, v67
    v_cvt_pk_bf16_f32 v86, v68, v69
    v_cvt_pk_bf16_f32 v87, v70, v71
    buffer_store_dwordx4 v[84:87], v79, s[36:39], s48 offen offset:3200 sc0 sc1
    s_branch k1_end
k1_sync:
    v_mov_b32 v117, 150272
    ds_read_b32 v118, v117
    s_waitcnt lgkmcnt(0)
    v_readfirstlane_b32 s54, v118
    s_nop 3
    s_cmp_eq_u32 s54, 0
    s_cbranch_scc1 k1_go
    s_cmp_lt_u32 s24, 12
    s_cbranch_scc1 k1_np
    s_mov_b32 s49, 64
k1_poll:
    s_lshl_b32 s54, s23, 8
    s_lshl_b32 s55, s30, 6
    s_add_u32 s54, s54, s55
    s_lshl_b32 s54, s54, 5
    s_lshl_b32 s55, s26, 4
    s_add_u32 s54, s54, s55
    s_add_u32 s54, s54, 25427968
    v_lshlrev_b32 v73, 5, v0
    buffer_load_dwordx4 v[76:79], v73, s[36:39], s54 offen sc0 sc1
    s_lshl_b32 s31, s35, 13
    s_lshl_b32 s55, s30, 8
    s_add_u32 s31, s31, s55
    s_add_u32 s31, s31, 25493504
    v_and_b32 v74, 15, v0
    v_lshlrev_b32 v74, 4, v74
    v_lshrrev_b32 v75, 4, v0
    v_lshl_add_u32 v75, v75, 11, v74
    buffer_load_dwordx4 v[80:83], v75, s[36:39], s31 offen sc0 sc1
    buffer_load_dwordx4 v[84:87], v75, s[36:39], s31 offen offset:1024 sc0 sc1
    s_waitcnt vmcnt(0)
    s_sub_u32 s49, s49, 1
    v_cmp_ne_u32 vcc, s48, v78
    v_cmp_ne_u32 s[54:55], s48, v82
    v_cmp_ne_u32 s[56:57], s48, v86
    s_nop 3
    s_or_b64 s[54:55], s[54:55], vcc
    s_or_b64 s[54:55], s[54:55], s[56:57]
    s_cmp_eq_u32 s48, 0
    s_cselect_b32 s54, 1, s54
    s_cmp_eq_u64 s[54:55], 0
    s_cselect_b32 s50, 1, 0
    s_cbranch_scc1 k1_got
    s_sleep 8
    s_cmp_lg_u32 s49, 0
    s_cbranch_scc1 k1_poll
    v_mov_b32 v73, 1
    ds_write_b32 v117, v73 offset:4
    s_waitcnt lgkmcnt(0)
    s_branch k1_np
k1_got:
    s_lshl_b32 s54, s30, 8
    v_lshlrev_b32 v72, 2, v0
    v_add_u32 v72, s54, v72
    v_add_u32 v72, 147456, v72
    ds_write_b32 v72, v76
    ds_write_b32 v72, v77 offset:1024
    v_add_f32 v80, v80, v84
    v_add_f32 v81, v81, v85
    v_mov_b32 v84, v80
    v_mov_b32 v85, v81
    s_nop 1
    v_permlane32_swap_b32 v80, v84
    v_permlane32_swap_b32 v81, v85
    s_nop 1
    v_add_f32 v80, v80, v84
    v_add_f32 v81, v81, v85
    v_mov_b32 v84, v80
    v_mov_b32 v85, v81
    s_nop 1
    v_permlane16_swap_b32 v80, v84
    v_permlane16_swap_b32 v81, v85
    s_nop 1
    v_add_f32 v80, v80, v84
    v_add_f32 v81, v81, v85
    s_lshl_b32 s54, s30, 7
    v_and_b32 v74, 15, v0
    v_lshlrev_b32 v74, 3, v74
    v_add_u32 v74, s54, v74
    v_add_u32 v74, 149504, v74
    ds_write_b64 v74, v[80:81]
    s_waitcnt lgkmcnt(0)
k1_np:
    s_barrier
    ds_read_b32 v118, v117 offset:4
    s_waitcnt lgkmcnt(0)
    v_readfirstlane_b32 s54, v118
    s_nop 3
    s_cmp_eq_u32 s54, 0
    s_cbranch_scc1 k1_go
    v_lshrrev_b32 v112, 4, v0
    v_mul_u32_u24 v112, 1280, v112
    v_and_b32 v115, 15, v0
    v_lshl_add_u32 v112, v115, 4, v112
    s_lshl_b32 s54, s23, 8
    s_lshl_b32 s55, s24, 4
    s_add_u32 s54, s54, s55
    s_mul_i32 s55, s54, 1280
    s_mov_b32 s57, 0x3f803f80
    s_lshl_b32 s56, s24, 6
    s_mov_b32 s54, 4
k1_fbr:
    buffer_load_dwordx4 v[72:75], v112, s[12:15], s55 offen offset:0
    buffer_load_dwordx4 v[76:79], v112, s[12:15], s55 offen offset:256
    buffer_load_dwordx4 v[80:83], v112, s[12:15], s55 offen offset:512
    buffer_load_dwordx4 v[84:87], v112, s[12:15], s55 offen offset:768
    buffer_load_dwordx4 v[88:91], v112, s[12:15], s55 offen offset:1024
    s_add_u32 s55, s55, 5120
    s_waitcnt vmcnt(0)
    v_mov_b32 v113, 0
    v_mov_b32 v114, 0
    v_dot2_f32_bf16 v113, v72, s57, v113
    v_dot2_f32_bf16 v114, v72, v72, v114
    v_dot2_f32_bf16 v113, v73, s57, v113
    v_dot2_f32_bf16 v114, v73, v73, v114
    v_dot2_f32_bf16 v113, v74, s57, v113
    v_dot2_f32_bf16 v114, v74, v74, v114
    v_dot2_f32_bf16 v113, v75, s57, v113
    v_dot2_f32_bf16 v114, v75, v75, v114
    v_dot2_f32_bf16 v113, v76, s57, v113
    v_dot2_f32_bf16 v114, v76, v76, v114
    v_dot2_f32_bf16 v113, v77, s57, v113
    v_dot2_f32_bf16 v114, v77, v77, v114
    v_dot2_f32_bf16 v113, v78, s57, v113
    v_dot2_f32_bf16 v114, v78, v78, v114
    v_dot2_f32_bf16 v113, v79, s57, v113
    v_dot2_f32_bf16 v114, v79, v79, v114
    v_dot2_f32_bf16 v113, v80, s57, v113
    v_dot2_f32_bf16 v114, v80, v80, v114
    v_dot2_f32_bf16 v113, v81, s57, v113
    v_dot2_f32_bf16 v114, v81, v81, v114
    v_dot2_f32_bf16 v113, v82, s57, v113
    v_dot2_f32_bf16 v114, v82, v82, v114
    v_dot2_f32_bf16 v113, v83, s57, v113
    v_dot2_f32_bf16 v114, v83, v83, v114
    v_dot2_f32_bf16 v113, v84, s57, v113
    v_dot2_f32_bf16 v114, v84, v84, v114
    v_dot2_f32_bf16 v113, v85, s57, v113
    v_dot2_f32_bf16 v114, v85, v85, v114
    v_dot2_f32_bf16 v113, v86, s57, v113
    v_dot2_f32_bf16 v114, v86, v86, v114
    v_dot2_f32_bf16 v113, v87, s57, v113
    v_dot2_f32_bf16 v114, v87, v87, v114
    v_dot2_f32_bf16 v113, v88, s57, v113
    v_dot2_f32_bf16 v114, v88, v88, v114
    v_dot2_f32_bf16 v113, v89, s57, v113
    v_dot2_f32_bf16 v114, v89, v89, v114
    v_dot2_f32_bf16 v113, v90, s57, v113
    v_dot2_f32_bf16 v114, v90, v90, v114
    v_dot2_f32_bf16 v113, v91, s57, v113
    v_dot2_f32_bf16 v114, v91, v91, v114
    s_nop 2
    v_add_f32_dpp v113, v113, v113 row_ror:8 row_mask:0xf bank_mask:0xf
    v_add_f32_dpp v114, v114, v114 row_ror:8 row_mask:0xf bank_mask:0xf
    s_nop 0
    v_add_f32_dpp v113, v113, v113 row_ror:4 row_mask:0xf bank_mask:0xf
    v_add_f32_dpp v114, v114, v114 row_ror:4 row_mask:0xf bank_mask:0xf
    s_nop 0
    v_add_f32_dpp v113, v113, v113 row_ror:2 row_mask:0xf bank_mask:0xf
    v_add_f32_dpp v114, v114, v114 row_ror:2 row_mask:0xf bank_mask:0xf
    s_nop 0
    v_add_f32_dpp v113, v113, v113 row_ror:1 row_mask:0xf bank_mask:0xf
    v_add_f32_dpp v114, v114, v114 row_ror:1 row_mask:0xf bank_mask:0xf
    s_nop 0
    v_mul_f32 v116, 0x3acccccd, v113
    v_mul_f32 v117, 0x3acccccd, v114
    v_fma_f32 v117, -v116, v116, v117
    v_max_f32 v117, 0, v117
    v_mov_b32 v119, v116
    v_cvt_pk_bf16_f32 v115, v119, v119
    v_lshlrev_b32 v119, 16, v115
    v_mov_b32 v118, v117
    v_cvt_pk_bf16_f32 v115, v118, v118
    v_lshlrev_b32 v118, 16, v115
    v_add_f32 v118, 0x3727c5ac, v118
    v_cvt_pk_bf16_f32 v115, v118, v118
    v_lshlrev_b32 v118, 16, v115
    v_sqrt_f32 v118, v118
    s_nop 0
    v_cvt_pk_bf16_f32 v115, v118, v118
    v_lshlrev_b32 v118, 16, v115
    v_rcp_f32 v73, v118
    v_mov_b32 v72, v119
    v_sub_f32 v76, v116, v119
    v_mul_f32 v76, v76, v73
    v_cvt_pk_bf16_f32 v115, v76, v76
    v_lshlrev_b32 v76, 16, v115
    v_mul_f32 v77, v117, v73
    v_mul_f32 v77, v77, v73
    v_cvt_pk_bf16_f32 v115, v77, v77
    v_lshlrev_b32 v77, 16, v115
    v_add_f32 v77, 0x3727c5ac, v77
    v_cvt_pk_bf16_f32 v115, v77, v77
    v_lshlrev_b32 v77, 16, v115
    v_sqrt_f32 v77, v77
    s_nop 0
    v_cvt_pk_bf16_f32 v115, v77, v77
    v_lshlrev_b32 v77, 16, v115
    v_rcp_f32 v77, v77
    v_fma_f32 v74, v76, v118, v119
    v_mul_f32 v75, v73, v77
    s_cmp_eq_u32 s26, 0
    s_cbranch_scc1 k1_fbq
    v_mov_b32 v72, v74
    v_mov_b32 v73, v75
k1_fbq:
    v_lshrrev_b32 v115, 4, v0
    v_lshlrev_b32 v115, 2, v115
    v_add_u32 v115, s56, v115
    v_add_u32 v115, 147456, v115
    ds_write_b32 v115, v72
    ds_write_b32 v115, v73 offset:1024
    s_waitcnt lgkmcnt(0)
    s_add_u32 s56, s56, 16
    s_sub_u32 s54, s54, 1
    s_cmp_lg_u32 s54, 0
    s_cbranch_scc1 k1_fbr
    s_cmp_eq_u32 s26, 0
    s_cselect_b32 s16, s6, s8
    s_cselect_b32 s17, s7, s9
    s_mov_b32 s55, 3456
    s_cselect_b32 s55, 3840, s55
    s_mov_b32 s18, 2211840
    s_cselect_b32 s18, 2457600, s18
    s_and_b32 s17, s17, 0xffff
    s_mov_b32 s19, 0x00020000
    s_mul_i32 s57, s24, 40
    s_mul_i32 s57, s57, s55
    s_add_u32 s56, s28, s57
    s_lshl_b32 s57, s55, 2
    v_lshrrev_b32 v110, 4, v0
    v_mul_lo_u32 v110, v110, s55
    v_and_b32 v111, 15, v0
    v_lshl_add_u32 v110, v111, 4, v110
    s_mov_b32 s58, 0x00003f80
    s_mov_b32 s59, 0x3f800000
    v_mov_b32 v112, 0
    v_mov_b32 v113, 0
    v_mov_b32 v114, 0
    v_mov_b32 v115, 0
    v_mov_b32 v116, 0
    v_mov_b32 v117, 0
    v_mov_b32 v118, 0
    v_mov_b32 v119, 0
    s_mov_b32 s54, 10
k1_fbc:
    buffer_load_dwordx4 v[72:75], v110, s[16:19], s56 offen
    s_add_u32 s56, s56, s57
    s_waitcnt vmcnt(0)
    v_dot2_f32_bf16 v112, v72, s58, v112
    v_dot2_f32_bf16 v113, v72, s59, v113
    v_dot2_f32_bf16 v114, v73, s58, v114
    v_dot2_f32_bf16 v115, v73, s59, v115
    v_dot2_f32_bf16 v116, v74, s58, v116
    v_dot2_f32_bf16 v117, v74, s59, v117
    v_dot2_f32_bf16 v118, v75, s58, v118
    v_dot2_f32_bf16 v119, v75, s59, v119
    s_sub_u32 s54, s54, 1
    s_cmp_lg_u32 s54, 0
    s_cbranch_scc1 k1_fbc
    s_nop 2
    v_mov_b32 v72, v112
    v_mov_b32 v73, v113
    v_mov_b32 v74, v114
    v_mov_b32 v75, v115
    v_mov_b32 v76, v116
    v_mov_b32 v77, v117
    v_mov_b32 v78, v118
    v_mov_b32 v79, v119
    s_nop 1
    v_permlane32_swap_b32 v112, v72
    v_permlane32_swap_b32 v113, v73
    v_permlane32_swap_b32 v114, v74
    v_permlane32_swap_b32 v115, v75
    v_permlane32_swap_b32 v116, v76
    v_permlane32_swap_b32 v117, v77
    v_permlane32_swap_b32 v118, v78
    v_permlane32_swap_b32 v119, v79
    s_nop 1
    v_add_f32 v112, v112, v72
    v_add_f32 v113, v113, v73
    v_add_f32 v114, v114, v74
    v_add_f32 v115, v115, v75
    v_add_f32 v116, v116, v76
    v_add_f32 v117, v117, v77
    v_add_f32 v118, v118, v78
    v_add_f32 v119, v119, v79
    v_mov_b32 v72, v112
    v_mov_b32 v73, v113
    v_mov_b32 v74, v114
    v_mov_b32 v75, v115
    v_mov_b32 v76, v116
    v_mov_b32 v77, v117
    v_mov_b32 v78, v118
    v_mov_b32 v79, v119
    s_nop 1
    v_permlane16_swap_b32 v112, v72
    v_permlane16_swap_b32 v113, v73
    v_permlane16_swap_b32 v114, v74
    v_permlane16_swap_b32 v115, v75
    v_permlane16_swap_b32 v116, v76
    v_permlane16_swap_b32 v117, v77
    v_permlane16_swap_b32 v118, v78
    v_permlane16_swap_b32 v119, v79
    s_nop 1
    v_add_f32 v112, v112, v72
    v_add_f32 v113, v113, v73
    v_add_f32 v114, v114, v74
    v_add_f32 v115, v115, v75
    v_add_f32 v116, v116, v76
    v_add_f32 v117, v117, v77
    v_add_f32 v118, v118, v78
    v_add_f32 v119, v119, v79
    s_lshl_b32 s54, s24, 9
    v_lshlrev_b32 v111, 5, v111
    v_add_u32 v111, s54, v111
    ds_write_b128 v111, v[112:115]
    ds_write_b128 v111, v[116:119] offset:16
    s_waitcnt lgkmcnt(0)
    s_barrier
    s_cmp_ge_u32 s24, 2
    s_cbranch_scc1 k1_fbs
    s_lshl_b32 s57, s24, 8
    v_lshlrev_b32 v111, 2, v0
    v_add_u32 v110, s57, v111
    ds_read_b32 v72, v110 offset:0
    ds_read_b32 v73, v110 offset:512
    ds_read_b32 v74, v110 offset:1024
    ds_read_b32 v75, v110 offset:1536
    ds_read_b32 v76, v110 offset:2048
    ds_read_b32 v77, v110 offset:2560
    ds_read_b32 v78, v110 offset:3072
    ds_read_b32 v79, v110 offset:3584
    ds_read_b32 v80, v110 offset:4096
    ds_read_b32 v81, v110 offset:4608
    ds_read_b32 v82, v110 offset:5120
    ds_read_b32 v83, v110 offset:5632
    ds_read_b32 v84, v110 offset:6144
    ds_read_b32 v85, v110 offset:6656
    ds_read_b32 v86, v110 offset:7168
    ds_read_b32 v87, v110 offset:7680
    s_waitcnt lgkmcnt(0)
    v_add_f32 v72, v72, v73
    v_add_f32 v72, v72, v74
    v_add_f32 v72, v72, v75
    v_add_f32 v72, v72, v76
    v_add_f32 v72, v72, v77
    v_add_f32 v72, v72, v78
    v_add_f32 v72, v72, v79
    v_add_f32 v72, v72, v80
    v_add_f32 v72, v72, v81
    v_add_f32 v72, v72, v82
    v_add_f32 v72, v72, v83
    v_add_f32 v72, v72, v84
    v_add_f32 v72, v72, v85
    v_add_f32 v72, v72, v86
    v_add_f32 v72, v72, v87
    v_add_u32 v110, 149504, v110
    ds_write_b32 v110, v72
    s_waitcnt lgkmcnt(0)
k1_fbs:
    s_barrier
k1_go:
    s_cmp_ge_u32 s24, 8
    s_cbranch_scc1 k1_end
    v_lshlrev_b32 v116, 4, v0
    s_cmp_eq_u32 s44, 1
    s_cbranch_scc1 k1_ret_mlp
    s_cmp_eq_u32 s44, 2
    s_cbranch_scc1 k1_ret_qk
    s_branch k1_ret_v
k1_end:
    s_waitcnt vmcnt(0)
k1_done:
    s_endpgm
.p2align 8
.globl attn_kernel
.type attn_kernel,@function
attn_kernel:
    s_cmp_ge_u32 s2, 416
    s_cbranch_scc1 k2_done
    s_load_dwordx2 s[4:5], s[0:1], 80
    s_load_dwordx2 s[6:7], s[0:1], 48
    s_load_dwordx2 s[8:9], s[0:1], 56
    v_lshrrev_b32 v1, 6, v0
    v_and_b32 v0, 63, v0
    s_and_b32 s20, s2, 7
    v_readfirstlane_b32 s24, v1
    s_cmp_ge_u32 s2, 256
    s_cbranch_scc1 k2_mlp
    s_lshr_b32 s21, s2, 3
    s_lshr_b32 s22, s21, 3
    s_lshl_b32 s23, s20, 2
    s_add_u32 s22, s22, s23
    s_and_b32 s23, s21, 7
    s_waitcnt lgkmcnt(0)
    s_mov_b32 s36, s4
    s_and_b32 s37, s5, 0xffff
    s_mov_b32 s38, 268435456
    s_mov_b32 s39, 0x00020000
    s_mul_i32 s25, s22, 163840
    s_add_u32 s25, s25, 7864320
    s_add_u32 s12, s4, s25
    s_addc_u32 s13, s5, 0
    s_and_b32 s13, s13, 0xffff
    s_mov_b32 s14, 163840
    s_mov_b32 s15, 0x00020000
    v_lshlrev_b32 v113, 4, v0
    s_cmp_lt_u32 s24, 4
    s_mul_i32 s26, s24, 3072
    s_lshl_b32 s27, s24, 11
    s_add_u32 s27, s27, 4096
    s_cmp_lt_u32 s24, 4
    s_cselect_b32 s26, s26, s27
    s_mov_b32 s30, s26
    s_mov_b32 s31, s26
    v_and_b32 v120, 31, v0
    v_lshlrev_b32 v114, 3, v120
    v_add_u32 v114, 1024, v114
    s_lshl_b32 s32, s23, 3
    s_add_u32 s32, s32, s24
    s_lshl_b32 s33, s22, 6
    s_add_u32 s33, s33, s32
    s_mul_i32 s33, s33, 1280
    s_add_u32 s33, s33, 5242880
    v_mov_b32 v8, 0
    v_mov_b32 v9, 0
    v_mov_b32 v10, 0
    v_mov_b32 v11, 0
    s_mov_b32 m0, s31
    s_cmp_lt_u32 s24, 4
    buffer_load_dwordx4 v113, s[12:15], s30 offen lds
    buffer_load_dwordx4 v113, s[12:15], s30 offen offset:1024 lds
    s_cbranch_scc0 k2_dmp0
    buffer_load_dwordx4 v113, s[12:15], s30 offen offset:2048 lds
k2_dmp0:
    s_add_u32 s31, s31, 20480
    s_add_u32 s30, s30, 20480
    s_cmp_ge_u32 s31, 61440
    s_cselect_b32 s31, s26, s31
    buffer_load_dwordx4 v[4:7], v113, s[36:39], s33 offen
    s_mov_b32 exec_hi, 0
    buffer_load_dwordx2 v[8:9], v114, s[36:39], s33 offen
    s_mov_b64 exec, -1
    s_mov_b32 m0, s31
    s_cmp_lt_u32 s24, 4
    buffer_load_dwordx4 v113, s[12:15], s30 offen lds
    buffer_load_dwordx4 v113, s[12:15], s30 offen offset:1024 lds
    s_cbranch_scc0 k2_dmp1
    buffer_load_dwordx4 v113, s[12:15], s30 offen offset:2048 lds
k2_dmp1:
    s_add_u32 s31, s31, 20480
    s_add_u32 s30, s30, 20480
    s_cmp_ge_u32 s31, 61440
    s_cselect_b32 s31, s26, s31
    v_lshrrev_b32 v121, 5, v0
    v_mad_u32_u24 v115, v121, 20, v120
    v_lshlrev_b32 v115, 4, v115
    v_add_u32 v115, 1280, v115
    s_mov_b32 s28, 0x000fffff
    s_mov_b32 s29, 0x000fffff
    v_and_b32 v122, 1, v0
    v_cmp_eq_u32 vcc, 0, v122
    v_mov_b32 v123, 0x3f803f80
    v_bfe_u32 v124, v0, 1, 1
    v_mul_u32_u24 v124, 640, v124
    v_lshl_add_u32 v124, v122, 4, v124
    v_cndmask_b32 v44, 0, v123, vcc
    v_cndmask_b32 v45, 0, v123, vcc
    v_cndmask_b32 v46, 0, v123, vcc
    v_cndmask_b32 v47, 0, v123, vcc
    ds_write_b128 v124, v[44:47] offset:61440
    v_cmp_gt_u32 vcc, 20, v120
    v_cmp_eq_u32 s[40:41], 20, v120
    v_mov_b32 v125, 61456
    v_mov_b32 v126, 61440
    v_cndmask_b32 v125, v125, v126, s[40:41]
    v_cndmask_b32 v110, v125, v115, vcc
    v_cndmask_b32 v118, 0, 1, vcc
    v_mul_u32_u24 v116, 2560, v118
    v_mov_b32 v16, 0
    v_mov_b32 v17, 0
    v_mov_b32 v18, 0
    v_mov_b32 v19, 0
    v_mov_b32 v24, 0
    v_mov_b32 v25, 0
    v_mov_b32 v26, 0
    v_mov_b32 v27, 0
    v_mov_b32 v28, 0
    v_mov_b32 v29, 0
    v_mov_b32 v30, 0
    v_mov_b32 v31, 0
    v_mov_b32 v32, 0
    v_mov_b32 v33, 0
    v_mov_b32 v34, 0
    v_mov_b32 v35, 0
    v_mov_b32 v36, 0
    v_mov_b32 v37, 0
    v_mov_b32 v38, 0
    v_mov_b32 v39, 0
    v_mov_b32 v40, 0
    v_mov_b32 v41, 0
    v_mov_b32 v42, 0
    v_mov_b32 v43, 0
    v_mov_b32 v84, 0
    v_mov_b32 v85, 0
    v_mov_b32 v86, 0
    v_mov_b32 v87, 0
    v_mov_b32 v88, 0
    v_mov_b32 v89, 0
    v_mov_b32 v90, 0
    v_mov_b32 v91, 0
    v_mov_b32 v92, 0
    v_mov_b32 v93, 0
    v_mov_b32 v94, 0
    v_mov_b32 v95, 0
    v_mov_b32 v96, 0
    v_mov_b32 v97, 0
    v_mov_b32 v98, 0
    v_mov_b32 v99, 0
    v_mov_b32 v100, 0
    v_mov_b32 v101, 0
    v_mov_b32 v102, 0
    v_mov_b32 v103, 0
    v_mov_b32 v104, 0
    v_mov_b32 v105, 0
    v_mov_b32 v106, 0
    v_mov_b32 v107, 0
    v_mov_b32 v111, v113
    v_mov_b32 v112, v114
    s_mov_b32 s34, 20480
    s_mov_b32 s35, 8
    s_waitcnt vmcnt(2) lgkmcnt(0)
    s_barrier
    ds_read_b128 v[12:15], v111 offset:0
    ds_read_b64 v[16:17], v112 offset:0
    ds_read_b128 v[20:23], v111 offset:2560
    ds_read_b64 v[24:25], v112 offset:2560
    s_waitcnt lgkmcnt(0)
    v_mfma_f32_32x32x16_bf16 v[44:59], v[12:15], v[4:7], 0
    v_mfma_f32_32x32x16_bf16 v[44:59], v[16:19], v[8:11], v[44:59]
    s_nop 7
k2_stage:
    s_waitcnt vmcnt(0)
    s_barrier
    s_mov_b32 m0, s31
    s_cmp_lt_u32 s24, 4
    buffer_load_dwordx4 v113, s[12:15], s30 offen lds
    buffer_load_dwordx4 v113, s[12:15], s30 offen offset:1024 lds
    s_cbranch_scc0 k2_dml
    buffer_load_dwordx4 v113, s[12:15], s30 offen offset:2048 lds
k2_dml:
    s_add_u32 s31, s31, 20480
    s_add_u32 s30, s30, 20480
    s_cmp_ge_u32 s31, 61440
    s_cselect_b32 s31, s26, s31
    v_mov_b32 v108, v111
    v_mov_b32 v109, v112
    v_add_u32 v111, s34, v113
    v_add_u32 v112, s34, v114
    s_cmp_eq_u32 s34, 0
    s_mov_b32 s27, 2560
    s_cselect_b32 s27, -58880, s27
    v_mul_lo_u32 v117, v118, s27
    s_add_u32 s34, s34, 20480
    s_cmp_eq_u32 s34, 61440
    s_cselect_b32 s34, 0, s34
    v_mfma_f32_32x32x16_bf16 v[60:75], v[20:23], v[4:7], 0
    v_exp_f32 v44, v44
    ds_read_b128 v[28:31], v110
    v_exp_f32 v45, v45
    v_exp_f32 v46, v46
    ds_read_b128 v[32:35], v110 offset:640
    v_exp_f32 v47, v47
    v_cvt_pk_bf16_f32 v76, v44, v45
    v_cvt_pk_bf16_f32 v77, v46, v47
    v_mfma_f32_32x32x16_bf16 v[60:75], v[24:27], v[8:11], v[60:75]
    v_exp_f32 v48, v48
    ds_read_b128 v[12:15], v108 offset:5120
    v_exp_f32 v49, v49
    v_exp_f32 v50, v50
    ds_read_b64 v[16:17], v109 offset:5120
    v_exp_f32 v51, v51
    v_cvt_pk_bf16_f32 v78, v48, v49
    v_cvt_pk_bf16_f32 v79, v50, v51
    v_mfma_f32_32x32x16_bf16 v[92:107], v[36:39], v[84:87], v[92:107]
    v_exp_f32 v52, v52
    v_add_u32 v110, v110, v116
    v_exp_f32 v53, v53
    v_exp_f32 v54, v54
    v_exp_f32 v55, v55
    v_cvt_pk_bf16_f32 v80, v52, v53
    v_cvt_pk_bf16_f32 v81, v54, v55
    v_mfma_f32_32x32x16_bf16 v[92:107], v[40:43], v[88:91], v[92:107]
    v_exp_f32 v56, v56
    v_exp_f32 v57, v57
    v_exp_f32 v58, v58
    s_waitcnt lgkmcnt(0)
    v_exp_f32 v59, v59
    v_cvt_pk_bf16_f32 v82, v56, v57
    v_cvt_pk_bf16_f32 v83, v58, v59
    v_mfma_f32_32x32x16_bf16 v[44:59], v[12:15], v[4:7], 0
    v_exp_f32 v60, v60
    ds_read_b128 v[36:39], v110
    v_exp_f32 v61, v61
    v_exp_f32 v62, v62
    ds_read_b128 v[40:43], v110 offset:640
    v_exp_f32 v63, v63
    v_cvt_pk_bf16_f32 v84, v60, v61
    v_cvt_pk_bf16_f32 v85, v62, v63
    v_mfma_f32_32x32x16_bf16 v[44:59], v[16:19], v[8:11], v[44:59]
    v_exp_f32 v64, v64
    ds_read_b128 v[20:23], v108 offset:7680
    v_exp_f32 v65, v65
    v_exp_f32 v66, v66
    ds_read_b64 v[24:25], v109 offset:7680
    v_exp_f32 v67, v67
    v_cvt_pk_bf16_f32 v86, v64, v65
    v_cvt_pk_bf16_f32 v87, v66, v67
    v_mfma_f32_32x32x16_bf16 v[92:107], v[28:31], v[76:79], v[92:107]
    v_exp_f32 v68, v68
    v_add_u32 v110, v110, v116
    v_exp_f32 v69, v69
    v_exp_f32 v70, v70
    v_exp_f32 v71, v71
    v_cvt_pk_bf16_f32 v88, v68, v69
    v_cvt_pk_bf16_f32 v89, v70, v71
    v_mfma_f32_32x32x16_bf16 v[92:107], v[32:35], v[80:83], v[92:107]
    v_exp_f32 v72, v72
    v_exp_f32 v73, v73
    v_exp_f32 v74, v74
    s_waitcnt lgkmcnt(0)
    v_exp_f32 v75, v75
    v_cvt_pk_bf16_f32 v90, v72, v73
    v_cvt_pk_bf16_f32 v91, v74, v75
    v_mfma_f32_32x32x16_bf16 v[60:75], v[20:23], v[4:7], 0
    v_exp_f32 v44, v44
    ds_read_b128 v[28:31], v110
    v_exp_f32 v45, v45
    v_exp_f32 v46, v46
    ds_read_b128 v[32:35], v110 offset:640
    v_exp_f32 v47, v47
    v_cvt_pk_bf16_f32 v76, v44, v45
    v_cvt_pk_bf16_f32 v77, v46, v47
    v_mfma_f32_32x32x16_bf16 v[60:75], v[24:27], v[8:11], v[60:75]
    v_exp_f32 v48, v48
    ds_read_b128 v[12:15], v108 offset:10240
    v_exp_f32 v49, v49
    v_exp_f32 v50, v50
    ds_read_b64 v[16:17], v109 offset:10240
    v_exp_f32 v51, v51
    v_cvt_pk_bf16_f32 v78, v48, v49
    v_cvt_pk_bf16_f32 v79, v50, v51
    v_mfma_f32_32x32x16_bf16 v[92:107], v[36:39], v[84:87], v[92:107]
    v_exp_f32 v52, v52
    v_add_u32 v110, v110, v116
    v_exp_f32 v53, v53
    v_exp_f32 v54, v54
    v_exp_f32 v55, v55
    v_cvt_pk_bf16_f32 v80, v52, v53
    v_cvt_pk_bf16_f32 v81, v54, v55
    v_mfma_f32_32x32x16_bf16 v[92:107], v[40:43], v[88:91], v[92:107]
    v_exp_f32 v56, v56
    v_exp_f32 v57, v57
    v_exp_f32 v58, v58
    s_waitcnt lgkmcnt(0)
    v_exp_f32 v59, v59
    v_cvt_pk_bf16_f32 v82, v56, v57
    v_cvt_pk_bf16_f32 v83, v58, v59
    v_mfma_f32_32x32x16_bf16 v[44:59], v[12:15], v[4:7], 0
    v_exp_f32 v60, v60
    ds_read_b128 v[36:39], v110
    v_exp_f32 v61, v61
    v_exp_f32 v62, v62
    ds_read_b128 v[40:43], v110 offset:640
    v_exp_f32 v63, v63
    v_cvt_pk_bf16_f32 v84, v60, v61
    v_cvt_pk_bf16_f32 v85, v62, v63
    v_mfma_f32_32x32x16_bf16 v[44:59], v[16:19], v[8:11], v[44:59]
    v_exp_f32 v64, v64
    ds_read_b128 v[20:23], v108 offset:12800
    v_exp_f32 v65, v65
    v_exp_f32 v66, v66
    ds_read_b64 v[24:25], v109 offset:12800
    v_exp_f32 v67, v67
    v_cvt_pk_bf16_f32 v86, v64, v65
    v_cvt_pk_bf16_f32 v87, v66, v67
    v_mfma_f32_32x32x16_bf16 v[92:107], v[28:31], v[76:79], v[92:107]
    v_exp_f32 v68, v68
    v_add_u32 v110, v110, v116
    v_exp_f32 v69, v69
    v_exp_f32 v70, v70
    v_exp_f32 v71, v71
    v_cvt_pk_bf16_f32 v88, v68, v69
    v_cvt_pk_bf16_f32 v89, v70, v71
    v_mfma_f32_32x32x16_bf16 v[92:107], v[32:35], v[80:83], v[92:107]
    v_exp_f32 v72, v72
    v_exp_f32 v73, v73
    v_exp_f32 v74, v74
    s_waitcnt lgkmcnt(0)
    v_exp_f32 v75, v75
    v_cvt_pk_bf16_f32 v90, v72, v73
    v_cvt_pk_bf16_f32 v91, v74, v75
    v_mfma_f32_32x32x16_bf16 v[60:75], v[20:23], v[4:7], 0
    v_exp_f32 v44, v44
    ds_read_b128 v[28:31], v110
    v_exp_f32 v45, v45
    v_exp_f32 v46, v46
    ds_read_b128 v[32:35], v110 offset:640
    v_exp_f32 v47, v47
    v_cvt_pk_bf16_f32 v76, v44, v45
    v_cvt_pk_bf16_f32 v77, v46, v47
    v_mfma_f32_32x32x16_bf16 v[60:75], v[24:27], v[8:11], v[60:75]
    v_exp_f32 v48, v48
    ds_read_b128 v[12:15], v108 offset:15360
    v_exp_f32 v49, v49
    v_exp_f32 v50, v50
    ds_read_b64 v[16:17], v109 offset:15360
    v_exp_f32 v51, v51
    v_cvt_pk_bf16_f32 v78, v48, v49
    v_cvt_pk_bf16_f32 v79, v50, v51
    v_mfma_f32_32x32x16_bf16 v[92:107], v[36:39], v[84:87], v[92:107]
    v_exp_f32 v52, v52
    v_add_u32 v110, v110, v116
    v_exp_f32 v53, v53
    v_exp_f32 v54, v54
    v_exp_f32 v55, v55
    v_cvt_pk_bf16_f32 v80, v52, v53
    v_cvt_pk_bf16_f32 v81, v54, v55
    v_mfma_f32_32x32x16_bf16 v[92:107], v[40:43], v[88:91], v[92:107]
    v_exp_f32 v56, v56
    v_exp_f32 v57, v57
    v_exp_f32 v58, v58
    s_waitcnt lgkmcnt(0)
    v_exp_f32 v59, v59
    v_cvt_pk_bf16_f32 v82, v56, v57
    v_cvt_pk_bf16_f32 v83, v58, v59
    v_mfma_f32_32x32x16_bf16 v[44:59], v[12:15], v[4:7], 0
    v_exp_f32 v60, v60
    ds_read_b128 v[36:39], v110
    v_exp_f32 v61, v61
    v_exp_f32 v62, v62
    ds_read_b128 v[40:43], v110 offset:640
    v_exp_f32 v63, v63
    v_cvt_pk_bf16_f32 v84, v60, v61
    v_cvt_pk_bf16_f32 v85, v62, v63
    v_mfma_f32_32x32x16_bf16 v[44:59], v[16:19], v[8:11], v[44:59]
    v_exp_f32 v64, v64
    ds_read_b128 v[20:23], v108 offset:17920
    v_exp_f32 v65, v65
    v_exp_f32 v66, v66
    ds_read_b64 v[24:25], v109 offset:17920
    v_exp_f32 v67, v67
    v_cvt_pk_bf16_f32 v86, v64, v65
    v_cvt_pk_bf16_f32 v87, v66, v67
    v_mfma_f32_32x32x16_bf16 v[92:107], v[28:31], v[76:79], v[92:107]
    v_exp_f32 v68, v68
    v_add_u32 v110, v110, v116
    v_exp_f32 v69, v69
    v_exp_f32 v70, v70
    v_exp_f32 v71, v71
    v_cvt_pk_bf16_f32 v88, v68, v69
    v_cvt_pk_bf16_f32 v89, v70, v71
    v_mfma_f32_32x32x16_bf16 v[92:107], v[32:35], v[80:83], v[92:107]
    v_exp_f32 v72, v72
    v_exp_f32 v73, v73
    v_exp_f32 v74, v74
    s_waitcnt lgkmcnt(0)
    v_exp_f32 v75, v75
    v_cvt_pk_bf16_f32 v90, v72, v73
    v_cvt_pk_bf16_f32 v91, v74, v75
    v_mfma_f32_32x32x16_bf16 v[60:75], v[20:23], v[4:7], 0
    v_exp_f32 v44, v44
    ds_read_b128 v[28:31], v110
    v_exp_f32 v45, v45
    v_exp_f32 v46, v46
    ds_read_b128 v[32:35], v110 offset:640
    v_exp_f32 v47, v47
    v_cvt_pk_bf16_f32 v76, v44, v45
    v_cvt_pk_bf16_f32 v77, v46, v47
    v_mfma_f32_32x32x16_bf16 v[60:75], v[24:27], v[8:11], v[60:75]
    v_exp_f32 v48, v48
    ds_read_b128 v[12:15], v111 offset:0
    v_exp_f32 v49, v49
    v_exp_f32 v50, v50
    ds_read_b64 v[16:17], v112 offset:0
    v_exp_f32 v51, v51
    v_cvt_pk_bf16_f32 v78, v48, v49
    v_cvt_pk_bf16_f32 v79, v50, v51
    v_mfma_f32_32x32x16_bf16 v[92:107], v[36:39], v[84:87], v[92:107]
    v_exp_f32 v52, v52
    v_add_u32 v110, v110, v116
    v_exp_f32 v53, v53
    v_exp_f32 v54, v54
    v_exp_f32 v55, v55
    v_cvt_pk_bf16_f32 v80, v52, v53
    v_cvt_pk_bf16_f32 v81, v54, v55
    v_mfma_f32_32x32x16_bf16 v[92:107], v[40:43], v[88:91], v[92:107]
    v_exp_f32 v56, v56
    v_exp_f32 v57, v57
    v_exp_f32 v58, v58
    s_waitcnt lgkmcnt(0)
    v_exp_f32 v59, v59
    v_cvt_pk_bf16_f32 v82, v56, v57
    v_cvt_pk_bf16_f32 v83, v58, v59
    v_mfma_f32_32x32x16_bf16 v[44:59], v[12:15], v[4:7], 0
    v_exp_f32 v60, v60
    ds_read_b128 v[36:39], v110
    v_exp_f32 v61, v61
    v_exp_f32 v62, v62
    ds_read_b128 v[40:43], v110 offset:640
    v_exp_f32 v63, v63
    v_cvt_pk_bf16_f32 v84, v60, v61
    v_cvt_pk_bf16_f32 v85, v62, v63
    v_mfma_f32_32x32x16_bf16 v[44:59], v[16:19], v[8:11], v[44:59]
    v_exp_f32 v64, v64
    ds_read_b128 v[20:23], v111 offset:2560
    v_exp_f32 v65, v65
    v_exp_f32 v66, v66
    ds_read_b64 v[24:25], v112 offset:2560
    v_exp_f32 v67, v67
    v_cvt_pk_bf16_f32 v86, v64, v65
    v_cvt_pk_bf16_f32 v87, v66, v67
    v_mfma_f32_32x32x16_bf16 v[92:107], v[28:31], v[76:79], v[92:107]
    v_exp_f32 v68, v68
    v_add_u32 v110, v110, v117
    v_exp_f32 v69, v69
    v_exp_f32 v70, v70
    v_exp_f32 v71, v71
    v_cvt_pk_bf16_f32 v88, v68, v69
    v_cvt_pk_bf16_f32 v89, v70, v71
    v_mfma_f32_32x32x16_bf16 v[92:107], v[32:35], v[80:83], v[92:107]
    v_exp_f32 v72, v72
    v_exp_f32 v73, v73
    v_exp_f32 v74, v74
    s_waitcnt lgkmcnt(0)
    v_exp_f32 v75, v75
    v_cvt_pk_bf16_f32 v90, v72, v73
    v_cvt_pk_bf16_f32 v91, v74, v75
    s_sub_u32 s35, s35, 1
    s_cmp_lg_u32 s35, 0
    s_cbranch_scc1 k2_stage
    v_mfma_f32_32x32x16_bf16 v[92:107], v[36:39], v[84:87], v[92:107]
    v_mfma_f32_32x32x16_bf16 v[92:107], v[40:43], v[88:91], v[92:107]
    s_waitcnt lgkmcnt(0) vmcnt(0)
    s_nop 15
    v_mov_b32 v124, 0
    v_mov_b32 v122, v100
    v_mov_b32 v120, v100
    s_nop 1
    v_permlane32_swap_b32 v122, v120
    v_fma_f32 v124, v92, 0, v124
    v_fma_f32 v124, v93, 0, v124
    v_fma_f32 v124, v94, 0, v124
    v_fma_f32 v124, v95, 0, v124
    v_fma_f32 v124, v96, 0, v124
    v_fma_f32 v124, v97, 0, v124
    v_fma_f32 v124, v98, 0, v124
    v_fma_f32 v124, v99, 0, v124
    v_fma_f32 v124, v100, 0, v124
    v_fma_f32 v124, v101, 0, v124
    v_fma_f32 v124, v102, 0, v124
    v_fma_f32 v124, v103, 0, v124
    s_mov_b32 s40, 0x17800000
    s_mov_b32 s41, 0x71800000
    v_cmp_u_f32 s[42:43], v124, v124
    v_cmp_nle_f32 s[44:45], s40, v120
    v_cmp_nge_f32 s[46:47], s41, v120
    s_nop 3
    s_or_b64 s[42:43], s[42:43], s[44:45]
    s_or_b64 s[42:43], s[42:43], s[46:47]
    s_cmp_eq_u64 s[42:43], 0
    s_cbranch_scc1 k2_epi
    v_and_b32 v122, 31, v0
    v_cmp_eq_u32 vcc, 20, v122
    v_mov_b32 v123, 0x3f803f80
    s_nop 0
    v_cndmask_b32 v28, 0, v123, vcc
    v_cndmask_b32 v29, 0, v123, vcc
    v_cndmask_b32 v30, 0, v123, vcc
    v_cndmask_b32 v31, 0, v123, vcc
    v_cndmask_b32 v32, 0, v123, vcc
    v_cndmask_b32 v33, 0, v123, vcc
    v_cndmask_b32 v34, 0, v123, vcc
    v_cndmask_b32 v35, 0, v123, vcc
    v_mov_b32 v126, 0xff800000
    s_mov_b32 s40, 0
k2_fb1:
    buffer_load_dwordx4 v[12:15], v113, s[12:15], s40 offen
    buffer_load_dwordx2 v[16:17], v114, s[12:15], s40 offen
    s_waitcnt vmcnt(0)
    v_mfma_f32_32x32x16_bf16 v[44:59], v[12:15], v[4:7], 0
    v_mfma_f32_32x32x16_bf16 v[44:59], v[16:19], v[8:11], v[44:59]
    s_nop 15
    s_nop 3
    v_max3_f32 v126, v44, v45, v126
    v_max3_f32 v126, v46, v47, v126
    v_max3_f32 v126, v48, v49, v126
    v_max3_f32 v126, v50, v51, v126
    v_max3_f32 v126, v52, v53, v126
    v_max3_f32 v126, v54, v55, v126
    v_max3_f32 v126, v56, v57, v126
    v_max3_f32 v126, v58, v59, v126
    s_add_u32 s40, s40, 2560
    s_cmp_lt_u32 s40, 163840
    s_cbranch_scc1 k2_fb1
    v_mov_b32 v127, v126
    s_nop 1
    v_permlane32_swap_b32 v126, v127
    s_nop 1
    v_max_f32 v126, v126, v127
    v_mov_b32 v92, 0
    v_mov_b32 v93, 0
    v_mov_b32 v94, 0
    v_mov_b32 v95, 0
    v_mov_b32 v96, 0
    v_mov_b32 v97, 0
    v_mov_b32 v98, 0
    v_mov_b32 v99, 0
    v_mov_b32 v100, 0
    v_mov_b32 v101, 0
    v_mov_b32 v102, 0
    v_mov_b32 v103, 0
    v_mov_b32 v104, 0
    v_mov_b32 v105, 0
    v_mov_b32 v106, 0
    v_mov_b32 v107, 0
    s_mov_b32 s40, 0
k2_fb2:
    buffer_load_dwordx4 v[12:15], v113, s[12:15], s40 offen
    buffer_load_dwordx2 v[16:17], v114, s[12:15], s40 offen
    s_mov_b64 exec, s[28:29]
    buffer_load_dwordx4 v[28:31], v115, s[12:15], s40 offen
    buffer_load_dwordx4 v[32:35], v115, s[12:15], s40 offen offset:640
    s_mov_b64 exec, -1
    s_waitcnt vmcnt(0)
    v_mfma_f32_32x32x16_bf16 v[44:59], v[12:15], v[4:7], 0
    v_mfma_f32_32x32x16_bf16 v[44:59], v[16:19], v[8:11], v[44:59]
    s_nop 15
    s_nop 3
    v_sub_f32 v44, v44, v126
    v_sub_f32 v45, v45, v126
    v_sub_f32 v46, v46, v126
    v_sub_f32 v47, v47, v126
    v_sub_f32 v48, v48, v126
    v_sub_f32 v49, v49, v126
    v_sub_f32 v50, v50, v126
    v_sub_f32 v51, v51, v126
    v_sub_f32 v52, v52, v126
    v_sub_f32 v53, v53, v126
    v_sub_f32 v54, v54, v126
    v_sub_f32 v55, v55, v126
    v_sub_f32 v56, v56, v126
    v_sub_f32 v57, v57, v126
    v_sub_f32 v58, v58, v126
    v_sub_f32 v59, v59, v126
    v_exp_f32 v44, v44
    v_exp_f32 v45, v45
    v_exp_f32 v46, v46
    v_exp_f32 v47, v47
    v_exp_f32 v48, v48
    v_exp_f32 v49, v49
    v_exp_f32 v50, v50
    v_exp_f32 v51, v51
    v_exp_f32 v52, v52
    v_exp_f32 v53, v53
    v_exp_f32 v54, v54
    v_exp_f32 v55, v55
    v_exp_f32 v56, v56
    v_exp_f32 v57, v57
    v_exp_f32 v58, v58
    v_exp_f32 v59, v59
    s_nop 0
    v_cvt_pk_bf16_f32 v76, v44, v45
    v_cvt_pk_bf16_f32 v77, v46, v47
    v_cvt_pk_bf16_f32 v78, v48, v49
    v_cvt_pk_bf16_f32 v79, v50, v51
    v_cvt_pk_bf16_f32 v80, v52, v53
    v_cvt_pk_bf16_f32 v81, v54, v55
    v_cvt_pk_bf16_f32 v82, v56, v57
    v_cvt_pk_bf16_f32 v83, v58, v59
    s_nop 1
    v_mfma_f32_32x32x16_bf16 v[92:107], v[28:31], v[76:79], v[92:107]
    v_mfma_f32_32x32x16_bf16 v[92:107], v[32:35], v[80:83], v[92:107]
    s_add_u32 s40, s40, 2560
    s_cmp_lt_u32 s40, 163840
    s_nop 7
    s_cbranch_scc1 k2_fb2
    s_nop 15
    v_mov_b32 v122, v100
    v_mov_b32 v120, v100
    s_nop 1
    v_permlane32_swap_b32 v122, v120
k2_epi:
    s_lshl_b32 s41, s22, 6
    s_add_u32 s41, s41, s32
    s_lshl_b32 s41, s41, 10
    s_add_u32 s41, s41, 20185088
    s_lshr_b32 s43, s22, 2
    s_add_u32 s43, s43, 32
    s_lshl_b32 s43, s43, 6
    s_add_u32 s43, s43, s32
    s_lshl_b32 s43, s43, 10
    s_bfe_u32 s44, s22, 0x10001
    s_lshl_b32 s44, s44, 9
    s_add_u32 s43, s43, s44
    s_and_b32 s44, s22, 1
    s_lshl_b32 s44, s44, 3
    s_add_u32 s43, s43, s44
    s_add_u32 s43, s43, 20185088
    v_rcp_f32 v120, v120
    s_nop 0
    v_mul_f32 v92, v92, v120
    v_mul_f32 v93, v93, v120
    v_mul_f32 v94, v94, v120
    v_mul_f32 v95, v95, v120
    v_mul_f32 v96, v96, v120
    v_mul_f32 v97, v97, v120
    v_mul_f32 v98, v98, v120
    v_mul_f32 v99, v99, v120
    v_mul_f32 v100, v100, v120
    v_mul_f32 v101, v101, v120
    v_mul_f32 v102, v102, v120
    v_mul_f32 v103, v103, v120
    v_cvt_pk_bf16_f32 v76, v92, v93
    v_cvt_pk_bf16_f32 v77, v94, v95
    v_cvt_pk_bf16_f32 v78, v96, v97
    v_cvt_pk_bf16_f32 v79, v98, v99
    v_cvt_pk_bf16_f32 v80, v100, v101
    v_cvt_pk_bf16_f32 v81, v102, v103
    buffer_store_dwordx4 v[76:79], v113, s[36:39], s41 offen sc0 sc1
    s_mov_b32 exec_hi, 0
    buffer_store_dwordx2 v[80:81], v113, s[36:39], s43 offen
    s_mov_b64 exec, -1
    s_branch k2_end
k2_mlp:
    s_sub_u32 s21, s2, 256
    s_lshr_b32 s21, s21, 3
    s_cmp_ge_u32 s21, 10
    s_cselect_b32 s22, 1, 0
    s_cselect_b32 s23, 10, 0
    s_sub_u32 s25, s21, s23
    s_lshl_b32 s23, s20, 1
    s_add_u32 s23, s23, s22
    s_lshl_b32 s28, s25, 7
    s_mov_b32 s29, 1280
    s_waitcnt lgkmcnt(0)
    s_mov_b32 s36, s4
    s_and_b32 s37, s5, 0xffff
    s_mov_b32 s38, 268435456
    s_mov_b32 s39, 0x00020000
    s_cmp_lt_u32 s24, 4
    s_cbranch_scc1 k2_mc
    s_cmp_gt_u32 s24, 4
    s_cbranch_scc1 k2_done
    s_add_u32 s16, s6, s28
    s_addc_u32 s17, s7, 0
    s_and_b32 s17, s17, 0xffff
    s_sub_u32 s18, 2211840, s28
    s_mov_b32 s19, 0x00020000
    s_add_u32 s12, s4, 13107200
    s_addc_u32 s13, s5, 0
    s_and_b32 s13, s13, 0xffff
    s_mov_b32 s14, 7077888
    s_mov_b32 s15, 0x00020000
    s_lshl_b32 s34, s23, 12
    v_lshlrev_b32 v68, 4, v0
    v_lshrrev_b32 v71, 3, v0
    v_and_b32 v72, 7, v0
    v_lshrrev_b32 v73, 2, v72
    v_bfe_u32 v74, v71, 1, 1
    v_xor_b32 v73, v73, v74
    v_and_b32 v72, 3, v72
    v_lshlrev_b32 v72, 4, v72
    v_lshl_add_u32 v72, v73, 6, v72
    v_mul_lo_u32 v73, v71, s29
    v_add_u32 v69, v73, v72
    s_mul_i32 s44, s29, 32
    s_mul_i32 s45, s29, 8
    s_mov_b32 s42, s34
    s_mov_b32 s43, 0
    s_mov_b32 s47, 0
    s_mov_b32 s41, 0
    s_cmp_lt_u32 s47, 54
    s_cselect_b32 s49, s42, 0x7ff00000
    s_cselect_b32 s50, s43, 0x7ff00000
    s_add_u32 m0, s41, 0
    s_add_u32 s48, s49, 0
    buffer_load_dwordx4 v68, s[12:15], s48 offen lds
    buffer_load_dwordx4 v68, s[12:15], s48 offen offset:1024 lds
    buffer_load_dwordx4 v68, s[12:15], s48 offen offset:2048 lds
    buffer_load_dwordx4 v68, s[12:15], s48 offen offset:3072 lds
    s_add_u32 m0, s41, 4096
    s_add_u32 s48, s49, 65536
    buffer_load_dwordx4 v68, s[12:15], s48 offen lds
    buffer_load_dwordx4 v68, s[12:15], s48 offen offset:1024 lds
    buffer_load_dwordx4 v68, s[12:15], s48 offen offset:2048 lds
    buffer_load_dwordx4 v68, s[12:15], s48 offen offset:3072 lds
    s_add_u32 m0, s41, 8192
    s_nop 0
    buffer_load_dwordx4 v69, s[16:19], s50 offen lds
    s_add_u32 m0, s41, 9216
    s_add_u32 s50, s50, s45
    buffer_load_dwordx4 v69, s[16:19], s50 offen lds
    s_add_u32 m0, s41, 10240
    s_add_u32 s50, s50, s45
    buffer_load_dwordx4 v69, s[16:19], s50 offen lds
    s_add_u32 m0, s41, 11264
    s_add_u32 s50, s50, s45
    buffer_load_dwordx4 v69, s[16:19], s50 offen lds
    s_add_u32 s42, s42, 131072
    s_add_u32 s43, s43, s44
    s_add_u32 s47, s47, 1
    s_add_u32 s41, s41, 12288
    s_cmp_eq_u32 s41, 61440
    s_cselect_b32 s41, 0, s41
    s_cmp_lt_u32 s47, 54
    s_cselect_b32 s49, s42, 0x7ff00000
    s_cselect_b32 s50, s43, 0x7ff00000
    s_add_u32 m0, s41, 0
    s_add_u32 s48, s49, 0
    buffer_load_dwordx4 v68, s[12:15], s48 offen lds
    buffer_load_dwordx4 v68, s[12:15], s48 offen offset:1024 lds
    buffer_load_dwordx4 v68, s[12:15], s48 offen offset:2048 lds
    buffer_load_dwordx4 v68, s[12:15], s48 offen offset:3072 lds
    s_add_u32 m0, s41, 4096
    s_add_u32 s48, s49, 65536
    buffer_load_dwordx4 v68, s[12:15], s48 offen lds
    buffer_load_dwordx4 v68, s[12:15], s48 offen offset:1024 lds
    buffer_load_dwordx4 v68, s[12:15], s48 offen offset:2048 lds
    buffer_load_dwordx4 v68, s[12:15], s48 offen offset:3072 lds
    s_add_u32 m0, s41, 8192
    s_nop 0
    buffer_load_dwordx4 v69, s[16:19], s50 offen lds
    s_add_u32 m0, s41, 9216
    s_add_u32 s50, s50, s45
    buffer_load_dwordx4 v69, s[16:19], s50 offen lds
    s_add_u32 m0, s41, 10240
    s_add_u32 s50, s50, s45
    buffer_load_dwordx4 v69, s[16:19], s50 offen lds
    s_add_u32 m0, s41, 11264
    s_add_u32 s50, s50, s45
    buffer_load_dwordx4 v69, s[16:19], s50 offen lds
    s_add_u32 s42, s42, 131072
    s_add_u32 s43, s43, s44
    s_add_u32 s47, s47, 1
    s_add_u32 s41, s41, 12288
    s_cmp_eq_u32 s41, 61440
    s_cselect_b32 s41, 0, s41
    s_waitcnt vmcnt(12)
    s_barrier
    s_cmp_lt_u32 s47, 54
    s_cselect_b32 s49, s42, 0x7ff00000
    s_cselect_b32 s50, s43, 0x7ff00000
    s_add_u32 m0, s41, 0
    s_add_u32 s48, s49, 0
    buffer_load_dwordx4 v68, s[12:15], s48 offen lds
    buffer_load_dwordx4 v68, s[12:15], s48 offen offset:1024 lds
    buffer_load_dwordx4 v68, s[12:15], s48 offen offset:2048 lds
    buffer_load_dwordx4 v68, s[12:15], s48 offen offset:3072 lds
    s_add_u32 m0, s41, 4096
    s_add_u32 s48, s49, 65536
    buffer_load_dwordx4 v68, s[12:15], s48 offen lds
    buffer_load_dwordx4 v68, s[12:15], s48 offen offset:1024 lds
    buffer_load_dwordx4 v68, s[12:15], s48 offen offset:2048 lds
    buffer_load_dwordx4 v68, s[12:15], s48 offen offset:3072 lds
    s_add_u32 m0, s41, 8192
    s_nop 0
    buffer_load_dwordx4 v69, s[16:19], s50 offen lds
    s_add_u32 m0, s41, 9216
    s_add_u32 s50, s50, s45
    buffer_load_dwordx4 v69, s[16:19], s50 offen lds
    s_add_u32 m0, s41, 10240
    s_add_u32 s50, s50, s45
    buffer_load_dwordx4 v69, s[16:19], s50 offen lds
    s_add_u32 m0, s41, 11264
    s_add_u32 s50, s50, s45
    buffer_load_dwordx4 v69, s[16:19], s50 offen lds
    s_add_u32 s42, s42, 131072
    s_add_u32 s43, s43, s44
    s_add_u32 s47, s47, 1
    s_add_u32 s41, s41, 12288
    s_cmp_eq_u32 s41, 61440
    s_cselect_b32 s41, 0, s41
    s_cmp_lt_u32 s47, 54
    s_cselect_b32 s49, s42, 0x7ff00000
    s_cselect_b32 s50, s43, 0x7ff00000
    s_add_u32 m0, s41, 0
    s_add_u32 s48, s49, 0
    buffer_load_dwordx4 v68, s[12:15], s48 offen lds
    buffer_load_dwordx4 v68, s[12:15], s48 offen offset:1024 lds
    buffer_load_dwordx4 v68, s[12:15], s48 offen offset:2048 lds
    buffer_load_dwordx4 v68, s[12:15], s48 offen offset:3072 lds
    s_add_u32 m0, s41, 4096
    s_add_u32 s48, s49, 65536
    buffer_load_dwordx4 v68, s[12:15], s48 offen lds
    buffer_load_dwordx4 v68, s[12:15], s48 offen offset:1024 lds
    buffer_load_dwordx4 v68, s[12:15], s48 offen offset:2048 lds
    buffer_load_dwordx4 v68, s[12:15], s48 offen offset:3072 lds
    s_add_u32 m0, s41, 8192
    s_nop 0
    buffer_load_dwordx4 v69, s[16:19], s50 offen lds
    s_add_u32 m0, s41, 9216
    s_add_u32 s50, s50, s45
    buffer_load_dwordx4 v69, s[16:19], s50 offen lds
    s_add_u32 m0, s41, 10240
    s_add_u32 s50, s50, s45
    buffer_load_dwordx4 v69, s[16:19], s50 offen lds
    s_add_u32 m0, s41, 11264
    s_add_u32 s50, s50, s45
    buffer_load_dwordx4 v69, s[16:19], s50 offen lds
    s_add_u32 s42, s42, 131072
    s_add_u32 s43, s43, s44
    s_add_u32 s47, s47, 1
    s_add_u32 s41, s41, 12288
    s_cmp_eq_u32 s41, 61440
    s_cselect_b32 s41, 0, s41
    s_mov_b32 s46, 54
k2_ld0_loop:
    s_waitcnt vmcnt(24)
    s_barrier
    s_cmp_lt_u32 s47, 54
    s_cselect_b32 s49, s42, 0x7ff00000
    s_cselect_b32 s50, s43, 0x7ff00000
    s_add_u32 m0, s41, 0
    s_add_u32 s48, s49, 0
    buffer_load_dwordx4 v68, s[12:15], s48 offen lds
    buffer_load_dwordx4 v68, s[12:15], s48 offen offset:1024 lds
    buffer_load_dwordx4 v68, s[12:15], s48 offen offset:2048 lds
    buffer_load_dwordx4 v68, s[12:15], s48 offen offset:3072 lds
    s_add_u32 m0, s41, 4096
    s_add_u32 s48, s49, 65536
    buffer_load_dwordx4 v68, s[12:15], s48 offen lds
    buffer_load_dwordx4 v68, s[12:15], s48 offen offset:1024 lds
    buffer_load_dwordx4 v68, s[12:15], s48 offen offset:2048 lds
    buffer_load_dwordx4 v68, s[12:15], s48 offen offset:3072 lds
    s_add_u32 m0, s41, 8192
    s_nop 0
    buffer_load_dwordx4 v69, s[16:19], s50 offen lds
    s_add_u32 m0, s41, 9216
    s_add_u32 s50, s50, s45
    buffer_load_dwordx4 v69, s[16:19], s50 offen lds
    s_add_u32 m0, s41, 10240
    s_add_u32 s50, s50, s45
    buffer_load_dwordx4 v69, s[16:19], s50 offen lds
    s_add_u32 m0, s41, 11264
    s_add_u32 s50, s50, s45
    buffer_load_dwordx4 v69, s[16:19], s50 offen lds
    s_add_u32 s42, s42, 131072
    s_add_u32 s43, s43, s44
    s_add_u32 s47, s47, 1
    s_add_u32 s41, s41, 12288
    s_cmp_eq_u32 s41, 61440
    s_cselect_b32 s41, 0, s41
    s_sub_u32 s46, s46, 1
    s_cmp_lg_u32 s46, 0
    s_cbranch_scc1 k2_ld0_loop
    s_branch k2_pf3
k2_pf3:
    s_branch k2_end
k2_mc:
    s_lshr_b32 s48, s24, 1
    s_and_b32 s49, s24, 1
    v_lshlrev_b32 v68, 4, v0
    s_mul_i32 s48, s48, 2048
    s_add_u32 s48, s48, 0
    v_add_u32 v64, s48, v68
    v_bfe_u32 v71, v0, 2, 2
    v_lshrrev_b32 v72, 5, v0
    v_mad_u32_u24 v72, v72, 4, v71
    v_mul_u32_u24 v72, 128, v72
    v_bfe_u32 v73, v0, 4, 1
    v_lshl_add_u32 v72, v73, 5, v72
    v_and_b32 v73, 3, v0
    v_lshl_add_u32 v72, v73, 3, v72
    v_add_u32 v72, 8192, v72
    v_lshrrev_b32 v71, 1, v71
    s_mul_i32 s48, s49, 1
    s_add_u32 s48, s48, 0
    v_xor_b32 v73, s48, v71
    v_lshl_add_u32 v65, v73, 6, v72
    s_mov_b32 s40, 0
    s_lshr_b32 s52, s24, 1
    s_and_b32 s53, s24, 1
    s_mov_b32 s60, s8
    s_and_b32 s61, s9, 0xffff
    s_mov_b32 s62, 1280
    s_mov_b32 s63, 0x00020000
    s_lshl_b32 s58, s53, 6
    s_add_u32 s58, s58, s28
    v_lshrrev_b32 v71, 5, v0
    v_lshlrev_b32 v71, 3, v71
    buffer_load_dwordx2 v[76:77], v71, s[60:63], s58 offen offset:0
    buffer_load_dwordx2 v[78:79], v71, s[60:63], s58 offen offset:16
    buffer_load_dwordx2 v[80:81], v71, s[60:63], s58 offen offset:32
    buffer_load_dwordx2 v[82:83], v71, s[60:63], s58 offen offset:48
    s_waitcnt vmcnt(0)
    v_lshlrev_b32 v8, 16, v76
    v_and_b32 v9, 0xffff0000, v76
    v_lshlrev_b32 v10, 16, v77
    v_and_b32 v11, 0xffff0000, v77
    v_lshlrev_b32 v24, 16, v76
    v_and_b32 v25, 0xffff0000, v76
    v_lshlrev_b32 v26, 16, v77
    v_and_b32 v27, 0xffff0000, v77
    v_lshlrev_b32 v12, 16, v78
    v_and_b32 v13, 0xffff0000, v78
    v_lshlrev_b32 v14, 16, v79
    v_and_b32 v15, 0xffff0000, v79
    v_lshlrev_b32 v28, 16, v78
    v_and_b32 v29, 0xffff0000, v78
    v_lshlrev_b32 v30, 16, v79
    v_and_b32 v31, 0xffff0000, v79
    v_lshlrev_b32 v16, 16, v80
    v_and_b32 v17, 0xffff0000, v80
    v_lshlrev_b32 v18, 16, v81
    v_and_b32 v19, 0xffff0000, v81
    v_lshlrev_b32 v32, 16, v80
    v_and_b32 v33, 0xffff0000, v80
    v_lshlrev_b32 v34, 16, v81
    v_and_b32 v35, 0xffff0000, v81
    v_lshlrev_b32 v20, 16, v82
    v_and_b32 v21, 0xffff0000, v82
    v_lshlrev_b32 v22, 16, v83
    v_and_b32 v23, 0xffff0000, v83
    v_lshlrev_b32 v36, 16, v82
    v_and_b32 v37, 0xffff0000, v82
    v_lshlrev_b32 v38, 16, v83
    v_and_b32 v39, 0xffff0000, v83
    v_add_u32 v66, s40, v64
    v_add_u32 v67, s40, v65
    s_mov_b32 s46, 54
    s_barrier
    ds_read_b128 v[40:43], v66 offset:0
    ds_read_b64_tr_b16 v[48:49], v67 offset:0
    ds_read_b64_tr_b16 v[50:51], v67 offset:1024
    ds_read_b128 v[44:47], v66 offset:1024
k2_m_loop:
    s_barrier
    s_waitcnt lgkmcnt(1)
    v_mfma_f32_32x32x16_bf16 v[8:23], v[48:51], v[40:43], v[8:23]
    ds_read_b128 v[52:55], v66 offset:4096
    ds_read_b64_tr_b16 v[60:61], v67 offset:2048
    ds_read_b64_tr_b16 v[62:63], v67 offset:3072
    ds_read_b128 v[56:59], v66 offset:5120
    s_waitcnt lgkmcnt(4)
    v_mfma_f32_32x32x16_bf16 v[24:39], v[48:51], v[44:47], v[24:39]
    s_waitcnt lgkmcnt(1)
    v_mfma_f32_32x32x16_bf16 v[8:23], v[60:63], v[52:55], v[8:23]
    s_add_u32 s40, s40, 12288
    s_cmp_eq_u32 s40, 61440
    s_cselect_b32 s40, 0, s40
    v_add_u32 v66, s40, v64
    v_add_u32 v67, s40, v65
    ds_read_b128 v[40:43], v66 offset:0
    ds_read_b64_tr_b16 v[48:49], v67 offset:0
    ds_read_b64_tr_b16 v[50:51], v67 offset:1024
    ds_read_b128 v[44:47], v66 offset:1024
    s_waitcnt lgkmcnt(4)
    v_mfma_f32_32x32x16_bf16 v[24:39], v[60:63], v[56:59], v[24:39]
    s_sub_u32 s46, s46, 1
    s_cmp_lg_u32 s46, 0
    s_cbranch_scc1 k2_m_loop
    s_waitcnt lgkmcnt(0)
    s_nop 15
    s_lshl_b32 s58, s23, 2
    s_lshl_b32 s59, s52, 1
    s_add_u32 s58, s58, s59
    s_mul_i32 s58, s58, 20
    s_lshl_b32 s59, s25, 1
    s_add_u32 s58, s58, s59
    s_add_u32 s58, s58, s53
    s_lshl_b32 s58, s58, 11
    s_add_u32 s58, s58, 22806528
    s_add_u32 s59, s58, 40960
    v_mov_b32 v76, 0xbfb8aa3b
    v_mul_f32 v80, v8, v76
    v_mul_f32 v81, v9, v76
    v_mul_f32 v82, v10, v76
    v_mul_f32 v83, v11, v76
    v_mul_f32 v84, v12, v76
    v_mul_f32 v85, v13, v76
    v_mul_f32 v86, v14, v76
    v_mul_f32 v87, v15, v76
    v_exp_f32 v80, v80
    v_exp_f32 v81, v81
    v_exp_f32 v82, v82
    v_exp_f32 v83, v83
    v_exp_f32 v84, v84
    v_exp_f32 v85, v85
    v_exp_f32 v86, v86
    v_exp_f32 v87, v87
    v_add_f32 v80, 1.0, v80
    v_add_f32 v81, 1.0, v81
    v_add_f32 v82, 1.0, v82
    v_add_f32 v83, 1.0, v83
    v_add_f32 v84, 1.0, v84
    v_add_f32 v85, 1.0, v85
    v_add_f32 v86, 1.0, v86
    v_add_f32 v87, 1.0, v87
    v_rcp_f32 v80, v80
    v_rcp_f32 v81, v81
    v_rcp_f32 v82, v82
    v_rcp_f32 v83, v83
    v_rcp_f32 v84, v84
    v_rcp_f32 v85, v85
    v_rcp_f32 v86, v86
    v_rcp_f32 v87, v87
    v_mul_f32 v80, v80, v8
    v_mul_f32 v81, v81, v9
    v_mul_f32 v82, v82, v10
    v_mul_f32 v83, v83, v11
    v_mul_f32 v84, v84, v12
    v_mul_f32 v85, v85, v13
    v_mul_f32 v86, v86, v14
    v_mul_f32 v87, v87, v15
    v_cvt_pk_bf16_f32 v96, v80, v81
    v_cvt_pk_bf16_f32 v97, v82, v83
    v_cvt_pk_bf16_f32 v98, v84, v85
    v_cvt_pk_bf16_f32 v99, v86, v87
    buffer_store_dwordx4 v[96:99], v68, s[36:39], s58 offen offset:0
    v_mul_f32 v88, v16, v76
    v_mul_f32 v89, v17, v76
    v_mul_f32 v90, v18, v76
    v_mul_f32 v91, v19, v76
    v_mul_f32 v92, v20, v76
    v_mul_f32 v93, v21, v76
    v_mul_f32 v94, v22, v76
    v_mul_f32 v95, v23, v76
    v_exp_f32 v88, v88
    v_exp_f32 v89, v89
    v_exp_f32 v90, v90
    v_exp_f32 v91, v91
    v_exp_f32 v92, v92
    v_exp_f32 v93, v93
    v_exp_f32 v94, v94
    v_exp_f32 v95, v95
    v_add_f32 v88, 1.0, v88
    v_add_f32 v89, 1.0, v89
    v_add_f32 v90, 1.0, v90
    v_add_f32 v91, 1.0, v91
    v_add_f32 v92, 1.0, v92
    v_add_f32 v93, 1.0, v93
    v_add_f32 v94, 1.0, v94
    v_add_f32 v95, 1.0, v95
    v_rcp_f32 v88, v88
    v_rcp_f32 v89, v89
    v_rcp_f32 v90, v90
    v_rcp_f32 v91, v91
    v_rcp_f32 v92, v92
    v_rcp_f32 v93, v93
    v_rcp_f32 v94, v94
    v_rcp_f32 v95, v95
    v_mul_f32 v88, v88, v16
    v_mul_f32 v89, v89, v17
    v_mul_f32 v90, v90, v18
    v_mul_f32 v91, v91, v19
    v_mul_f32 v92, v92, v20
    v_mul_f32 v93, v93, v21
    v_mul_f32 v94, v94, v22
    v_mul_f32 v95, v95, v23
    v_cvt_pk_bf16_f32 v100, v88, v89
    v_cvt_pk_bf16_f32 v101, v90, v91
    v_cvt_pk_bf16_f32 v102, v92, v93
    v_cvt_pk_bf16_f32 v103, v94, v95
    buffer_store_dwordx4 v[100:103], v68, s[36:39], s58 offen offset:1024
    v_mul_f32 v80, v24, v76
    v_mul_f32 v81, v25, v76
    v_mul_f32 v82, v26, v76
    v_mul_f32 v83, v27, v76
    v_mul_f32 v84, v28, v76
    v_mul_f32 v85, v29, v76
    v_mul_f32 v86, v30, v76
    v_mul_f32 v87, v31, v76
    v_exp_f32 v80, v80
    v_exp_f32 v81, v81
    v_exp_f32 v82, v82
    v_exp_f32 v83, v83
    v_exp_f32 v84, v84
    v_exp_f32 v85, v85
    v_exp_f32 v86, v86
    v_exp_f32 v87, v87
    v_add_f32 v80, 1.0, v80
    v_add_f32 v81, 1.0, v81
    v_add_f32 v82, 1.0, v82
    v_add_f32 v83, 1.0, v83
    v_add_f32 v84, 1.0, v84
    v_add_f32 v85, 1.0, v85
    v_add_f32 v86, 1.0, v86
    v_add_f32 v87, 1.0, v87
    v_rcp_f32 v80, v80
    v_rcp_f32 v81, v81
    v_rcp_f32 v82, v82
    v_rcp_f32 v83, v83
    v_rcp_f32 v84, v84
    v_rcp_f32 v85, v85
    v_rcp_f32 v86, v86
    v_rcp_f32 v87, v87
    v_mul_f32 v80, v80, v24
    v_mul_f32 v81, v81, v25
    v_mul_f32 v82, v82, v26
    v_mul_f32 v83, v83, v27
    v_mul_f32 v84, v84, v28
    v_mul_f32 v85, v85, v29
    v_mul_f32 v86, v86, v30
    v_mul_f32 v87, v87, v31
    v_cvt_pk_bf16_f32 v96, v80, v81
    v_cvt_pk_bf16_f32 v97, v82, v83
    v_cvt_pk_bf16_f32 v98, v84, v85
    v_cvt_pk_bf16_f32 v99, v86, v87
    buffer_store_dwordx4 v[96:99], v68, s[36:39], s59 offen offset:0
    v_mul_f32 v88, v32, v76
    v_mul_f32 v89, v33, v76
    v_mul_f32 v90, v34, v76
    v_mul_f32 v91, v35, v76
    v_mul_f32 v92, v36, v76
    v_mul_f32 v93, v37, v76
    v_mul_f32 v94, v38, v76
    v_mul_f32 v95, v39, v76
    v_exp_f32 v88, v88
    v_exp_f32 v89, v89
    v_exp_f32 v90, v90
    v_exp_f32 v91, v91
    v_exp_f32 v92, v92
    v_exp_f32 v93, v93
    v_exp_f32 v94, v94
    v_exp_f32 v95, v95
    v_add_f32 v88, 1.0, v88
    v_add_f32 v89, 1.0, v89
    v_add_f32 v90, 1.0, v90
    v_add_f32 v91, 1.0, v91
    v_add_f32 v92, 1.0, v92
    v_add_f32 v93, 1.0, v93
    v_add_f32 v94, 1.0, v94
    v_add_f32 v95, 1.0, v95
    v_rcp_f32 v88, v88
    v_rcp_f32 v89, v89
    v_rcp_f32 v90, v90
    v_rcp_f32 v91, v91
    v_rcp_f32 v92, v92
    v_rcp_f32 v93, v93
    v_rcp_f32 v94, v94
    v_rcp_f32 v95, v95
    v_mul_f32 v88, v88, v32
    v_mul_f32 v89, v89, v33
    v_mul_f32 v90, v90, v34
    v_mul_f32 v91, v91, v35
    v_mul_f32 v92, v92, v36
    v_mul_f32 v93, v93, v37
    v_mul_f32 v94, v94, v38
    v_mul_f32 v95, v95, v39
    v_cvt_pk_bf16_f32 v100, v88, v89
    v_cvt_pk_bf16_f32 v101, v90, v91
    v_cvt_pk_bf16_f32 v102, v92, v93
    v_cvt_pk_bf16_f32 v103, v94, v95
    buffer_store_dwordx4 v[100:103], v68, s[36:39], s59 offen offset:1024
k2_end:
    s_waitcnt vmcnt(0)
k2_done:
    s_endpgm
.p2align 8
.globl out_kernel
.type out_kernel,@function
out_kernel:
    s_cmp_ge_u32 s2, 160
    s_cbranch_scc1 k3_done
    s_load_dwordx2 s[4:5], s[0:1], 80
    s_load_dwordx2 s[6:7], s[0:1], 16
    s_load_dwordx2 s[8:9], s[0:1], 0
    s_load_dwordx2 s[10:11], s[0:1], 64
    v_lshrrev_b32 v1, 6, v0
    v_and_b32 v0, 63, v0
    s_and_b32 s20, s2, 7
    v_readfirstlane_b32 s24, v1
    s_lshr_b32 s21, s2, 3
    s_cmp_ge_u32 s21, 10
    s_cselect_b32 s22, 1, 0
    s_cselect_b32 s23, 10, 0
    s_sub_u32 s25, s21, s23
    s_lshl_b32 s23, s20, 1
    s_add_u32 s23, s23, s22
    s_lshl_b32 s28, s25, 7
    s_mov_b32 s29, 1280
    s_waitcnt lgkmcnt(0)
    s_mov_b32 s36, s4
    s_and_b32 s37, s5, 0xffff
    s_mov_b32 s38, 268435456
    s_mov_b32 s39, 0x00020000
    s_cmp_lt_u32 s24, 8
    s_cbranch_scc1 k3_c
    s_add_u32 s16, s6, s28
    s_addc_u32 s17, s7, 0
    s_and_b32 s17, s17, 0xffff
    s_sub_u32 s18, 819200, s28
    s_mov_b32 s19, 0x00020000
    s_add_u32 s12, s4, 20185088
    s_addc_u32 s13, s5, 0
    s_and_b32 s13, s13, 0xffff
    s_mov_b32 s14, 2621440
    s_mov_b32 s15, 0x00020000
    s_lshl_b32 s34, s23, 12
    v_lshlrev_b32 v44, 4, v0
    v_lshrrev_b32 v47, 3, v0
    v_and_b32 v48, 7, v0
    v_lshrrev_b32 v49, 2, v48
    v_bfe_u32 v50, v47, 1, 1
    v_xor_b32 v49, v49, v50
    v_and_b32 v48, 3, v48
    v_lshlrev_b32 v48, 4, v48
    v_lshl_add_u32 v48, v49, 6, v48
    v_mul_lo_u32 v49, v47, s29
    v_add_u32 v45, v49, v48
    s_mul_i32 s52, s29, 64
    s_mul_i32 s53, s29, 8
    s_mov_b32 s50, s34
    s_mov_b32 s51, 0
    s_mov_b32 s55, 0
    s_mov_b32 s49, 0
    v_lshrrev_b32 v49, 2, v47
    v_mul_u32_u24 v49, 40, v49
    v_and_b32 v50, 3, v47
    v_add_u32 v49, v49, v50
    v_mul_u32_u24 v49, 1280, v49
    v_add_u32 v46, v49, v48
    s_cmp_eq_u32 s24, 9
    s_cbranch_scc1 k3_ld1
    s_cmp_eq_u32 s24, 10
    s_cbranch_scc1 k3_ld2
    s_cmp_eq_u32 s24, 11
    s_cbranch_scc1 k3_ld3
    s_mov_b32 m0, 0
    s_add_u32 s56, s34, 0
    buffer_load_dwordx4 v44, s[12:15], s56 offen lds
    buffer_load_dwordx4 v44, s[12:15], s56 offen offset:1024 lds
    buffer_load_dwordx4 v44, s[12:15], s56 offen offset:2048 lds
    buffer_load_dwordx4 v44, s[12:15], s56 offen offset:3072 lds
    s_mov_b32 m0, 16384
    s_mov_b32 s56, 0
    buffer_load_dwordx4 v45, s[16:19], s56 offen lds
    s_mov_b32 m0, 17408
    s_mov_b32 s56, 10240
    buffer_load_dwordx4 v45, s[16:19], s56 offen lds
    s_mov_b32 m0, 24576
    s_add_u32 s56, s34, 262144
    buffer_load_dwordx4 v44, s[12:15], s56 offen lds
    buffer_load_dwordx4 v44, s[12:15], s56 offen offset:1024 lds
    buffer_load_dwordx4 v44, s[12:15], s56 offen offset:2048 lds
    buffer_load_dwordx4 v44, s[12:15], s56 offen offset:3072 lds
    s_mov_b32 m0, 40960
    s_mov_b32 s56, 102400
    buffer_load_dwordx4 v45, s[16:19], s56 offen lds
    s_mov_b32 m0, 41984
    s_mov_b32 s56, 112640
    buffer_load_dwordx4 v45, s[16:19], s56 offen lds
    s_waitcnt vmcnt(6)
    s_barrier
    s_mov_b32 m0, 49152
    s_add_u32 s56, s34, 524288
    buffer_load_dwordx4 v44, s[12:15], s56 offen lds
    buffer_load_dwordx4 v44, s[12:15], s56 offen offset:1024 lds
    buffer_load_dwordx4 v44, s[12:15], s56 offen offset:2048 lds
    buffer_load_dwordx4 v44, s[12:15], s56 offen offset:3072 lds
    s_mov_b32 m0, 65536
    s_mov_b32 s56, 204800
    buffer_load_dwordx4 v45, s[16:19], s56 offen lds
    s_mov_b32 m0, 66560
    s_mov_b32 s56, 215040
    buffer_load_dwordx4 v45, s[16:19], s56 offen lds
    s_mov_b32 m0, 73728
    s_add_u32 s56, s34, 786432
    buffer_load_dwordx4 v44, s[12:15], s56 offen lds
    buffer_load_dwordx4 v44, s[12:15], s56 offen offset:1024 lds
    buffer_load_dwordx4 v44, s[12:15], s56 offen offset:2048 lds
    buffer_load_dwordx4 v44, s[12:15], s56 offen offset:3072 lds
    s_mov_b32 m0, 90112
    s_mov_b32 s56, 307200
    buffer_load_dwordx4 v45, s[16:19], s56 offen lds
    s_mov_b32 m0, 91136
    s_mov_b32 s56, 317440
    buffer_load_dwordx4 v45, s[16:19], s56 offen lds
    s_mov_b32 m0, 98304
    s_add_u32 s56, s34, 1048576
    buffer_load_dwordx4 v44, s[12:15], s56 offen lds
    buffer_load_dwordx4 v44, s[12:15], s56 offen offset:1024 lds
    buffer_load_dwordx4 v44, s[12:15], s56 offen offset:2048 lds
    buffer_load_dwordx4 v44, s[12:15], s56 offen offset:3072 lds
    s_mov_b32 m0, 114688
    s_mov_b32 s56, 409600
    buffer_load_dwordx4 v45, s[16:19], s56 offen lds
    s_mov_b32 m0, 115712
    s_mov_b32 s56, 419840
    buffer_load_dwordx4 v45, s[16:19], s56 offen lds
    s_waitcnt vmcnt(18)
    s_barrier
    s_mov_b32 m0, 122880
    s_add_u32 s56, s34, 1310720
    buffer_load_dwordx4 v44, s[12:15], s56 offen lds
    buffer_load_dwordx4 v44, s[12:15], s56 offen offset:1024 lds
    buffer_load_dwordx4 v44, s[12:15], s56 offen offset:2048 lds
    buffer_load_dwordx4 v44, s[12:15], s56 offen offset:3072 lds
    s_mov_b32 m0, 139264
    s_mov_b32 s56, 512000
    buffer_load_dwordx4 v45, s[16:19], s56 offen lds
    s_mov_b32 m0, 140288
    s_mov_b32 s56, 522240
    buffer_load_dwordx4 v45, s[16:19], s56 offen lds
    s_waitcnt vmcnt(18)
    s_barrier
    s_mov_b32 m0, 0
    s_add_u32 s56, s34, 1572864
    buffer_load_dwordx4 v44, s[12:15], s56 offen lds
    buffer_load_dwordx4 v44, s[12:15], s56 offen offset:1024 lds
    buffer_load_dwordx4 v44, s[12:15], s56 offen offset:2048 lds
    buffer_load_dwordx4 v44, s[12:15], s56 offen offset:3072 lds
    s_mov_b32 m0, 16384
    s_mov_b32 s56, 614400
    buffer_load_dwordx4 v45, s[16:19], s56 offen lds
    s_mov_b32 m0, 17408
    s_mov_b32 s56, 624640
    buffer_load_dwordx4 v45, s[16:19], s56 offen lds
    s_waitcnt vmcnt(18)
    s_barrier
    s_mov_b32 m0, 24576
    s_add_u32 s56, s34, 1835008
    buffer_load_dwordx4 v44, s[12:15], s56 offen lds
    buffer_load_dwordx4 v44, s[12:15], s56 offen offset:1024 lds
    buffer_load_dwordx4 v44, s[12:15], s56 offen offset:2048 lds
    buffer_load_dwordx4 v44, s[12:15], s56 offen offset:3072 lds
    s_mov_b32 m0, 40960
    s_mov_b32 s56, 716800
    buffer_load_dwordx4 v45, s[16:19], s56 offen lds
    s_mov_b32 m0, 41984
    s_mov_b32 s56, 727040
    buffer_load_dwordx4 v45, s[16:19], s56 offen lds
    s_waitcnt vmcnt(18)
    s_barrier
    s_mov_b32 m0, 49152
    s_add_u32 s56, s34, 2097152
    buffer_load_dwordx4 v44, s[12:15], s56 offen lds
    buffer_load_dwordx4 v44, s[12:15], s56 offen offset:1024 lds
    buffer_load_dwordx4 v44, s[12:15], s56 offen offset:2048 lds
    buffer_load_dwordx4 v44, s[12:15], s56 offen offset:3072 lds
    s_mov_b32 m0, 65536
    s_mov_b32 s56, 20480
    buffer_load_dwordx4 v46, s[16:19], s56 offen lds
    s_mov_b32 m0, 66560
    s_mov_b32 s56, 46080
    buffer_load_dwordx4 v46, s[16:19], s56 offen lds
    s_waitcnt vmcnt(18)
    s_barrier
    s_mov_b32 m0, 73728
    s_add_u32 s56, s34, 2359296
    buffer_load_dwordx4 v44, s[12:15], s56 offen lds
    buffer_load_dwordx4 v44, s[12:15], s56 offen offset:1024 lds
    buffer_load_dwordx4 v44, s[12:15], s56 offen offset:2048 lds
    buffer_load_dwordx4 v44, s[12:15], s56 offen offset:3072 lds
    s_mov_b32 m0, 90112
    s_mov_b32 s56, 430080
    buffer_load_dwordx4 v46, s[16:19], s56 offen lds
    s_mov_b32 m0, 91136
    s_mov_b32 s56, 455680
    buffer_load_dwordx4 v46, s[16:19], s56 offen lds
    s_waitcnt vmcnt(18)
    s_barrier
    s_waitcnt vmcnt(12)
    s_barrier
    s_waitcnt vmcnt(6)
    s_barrier
    s_waitcnt vmcnt(0)
    s_barrier
    s_waitcnt vmcnt(0)
    s_barrier
    s_branch k3_end
k3_ld1:
    s_mov_b32 m0, 4096
    s_add_u32 s56, s34, 65536
    buffer_load_dwordx4 v44, s[12:15], s56 offen lds
    buffer_load_dwordx4 v44, s[12:15], s56 offen offset:1024 lds
    buffer_load_dwordx4 v44, s[12:15], s56 offen offset:2048 lds
    buffer_load_dwordx4 v44, s[12:15], s56 offen offset:3072 lds
    s_mov_b32 m0, 18432
    s_mov_b32 s56, 25600
    buffer_load_dwordx4 v45, s[16:19], s56 offen lds
    s_mov_b32 m0, 19456
    s_mov_b32 s56, 35840
    buffer_load_dwordx4 v45, s[16:19], s56 offen lds
    s_mov_b32 m0, 28672
    s_add_u32 s56, s34, 327680
    buffer_load_dwordx4 v44, s[12:15], s56 offen lds
    buffer_load_dwordx4 v44, s[12:15], s56 offen offset:1024 lds
    buffer_load_dwordx4 v44, s[12:15], s56 offen offset:2048 lds
    buffer_load_dwordx4 v44, s[12:15], s56 offen offset:3072 lds
    s_mov_b32 m0, 43008
    s_mov_b32 s56, 128000
    buffer_load_dwordx4 v45, s[16:19], s56 offen lds
    s_mov_b32 m0, 44032
    s_mov_b32 s56, 138240
    buffer_load_dwordx4 v45, s[16:19], s56 offen lds
    s_waitcnt vmcnt(6)
    s_barrier
    s_mov_b32 m0, 53248
    s_add_u32 s56, s34, 589824
    buffer_load_dwordx4 v44, s[12:15], s56 offen lds
    buffer_load_dwordx4 v44, s[12:15], s56 offen offset:1024 lds
    buffer_load_dwordx4 v44, s[12:15], s56 offen offset:2048 lds
    buffer_load_dwordx4 v44, s[12:15], s56 offen offset:3072 lds
    s_mov_b32 m0, 67584
    s_mov_b32 s56, 230400
    buffer_load_dwordx4 v45, s[16:19], s56 offen lds
    s_mov_b32 m0, 68608
    s_mov_b32 s56, 240640
    buffer_load_dwordx4 v45, s[16:19], s56 offen lds
    s_mov_b32 m0, 77824
    s_add_u32 s56, s34, 851968
    buffer_load_dwordx4 v44, s[12:15], s56 offen lds
    buffer_load_dwordx4 v44, s[12:15], s56 offen offset:1024 lds
    buffer_load_dwordx4 v44, s[12:15], s56 offen offset:2048 lds
    buffer_load_dwordx4 v44, s[12:15], s56 offen offset:3072 lds
    s_mov_b32 m0, 92160
    s_mov_b32 s56, 332800
    buffer_load_dwordx4 v45, s[16:19], s56 offen lds
    s_mov_b32 m0, 93184
    s_mov_b32 s56, 343040
    buffer_load_dwordx4 v45, s[16:19], s56 offen lds
    s_mov_b32 m0, 102400
    s_add_u32 s56, s34, 1114112
    buffer_load_dwordx4 v44, s[12:15], s56 offen lds
    buffer_load_dwordx4 v44, s[12:15], s56 offen offset:1024 lds
    buffer_load_dwordx4 v44, s[12:15], s56 offen offset:2048 lds
    buffer_load_dwordx4 v44, s[12:15], s56 offen offset:3072 lds
    s_mov_b32 m0, 116736
    s_mov_b32 s56, 435200
    buffer_load_dwordx4 v45, s[16:19], s56 offen lds
    s_mov_b32 m0, 117760
    s_mov_b32 s56, 445440
    buffer_load_dwordx4 v45, s[16:19], s56 offen lds
    s_waitcnt vmcnt(18)
    s_barrier
    s_mov_b32 m0, 126976
    s_add_u32 s56, s34, 1376256
    buffer_load_dwordx4 v44, s[12:15], s56 offen lds
    buffer_load_dwordx4 v44, s[12:15], s56 offen offset:1024 lds
    buffer_load_dwordx4 v44, s[12:15], s56 offen offset:2048 lds
    buffer_load_dwordx4 v44, s[12:15], s56 offen offset:3072 lds
    s_mov_b32 m0, 141312
    s_mov_b32 s56, 537600
    buffer_load_dwordx4 v45, s[16:19], s56 offen lds
    s_mov_b32 m0, 142336
    s_mov_b32 s56, 547840
    buffer_load_dwordx4 v45, s[16:19], s56 offen lds
    s_waitcnt vmcnt(18)
    s_barrier
    s_mov_b32 m0, 4096
    s_add_u32 s56, s34, 1638400
    buffer_load_dwordx4 v44, s[12:15], s56 offen lds
    buffer_load_dwordx4 v44, s[12:15], s56 offen offset:1024 lds
    buffer_load_dwordx4 v44, s[12:15], s56 offen offset:2048 lds
    buffer_load_dwordx4 v44, s[12:15], s56 offen offset:3072 lds
    s_mov_b32 m0, 18432
    s_mov_b32 s56, 640000
    buffer_load_dwordx4 v45, s[16:19], s56 offen lds
    s_mov_b32 m0, 19456
    s_mov_b32 s56, 650240
    buffer_load_dwordx4 v45, s[16:19], s56 offen lds
    s_waitcnt vmcnt(18)
    s_barrier
    s_mov_b32 m0, 28672
    s_add_u32 s56, s34, 1900544
    buffer_load_dwordx4 v44, s[12:15], s56 offen lds
    buffer_load_dwordx4 v44, s[12:15], s56 offen offset:1024 lds
    buffer_load_dwordx4 v44, s[12:15], s56 offen offset:2048 lds
    buffer_load_dwordx4 v44, s[12:15], s56 offen offset:3072 lds
    s_mov_b32 m0, 43008
    s_mov_b32 s56, 742400
    buffer_load_dwordx4 v45, s[16:19], s56 offen lds
    s_mov_b32 m0, 44032
    s_mov_b32 s56, 752640
    buffer_load_dwordx4 v45, s[16:19], s56 offen lds
    s_waitcnt vmcnt(18)
    s_barrier
    s_mov_b32 m0, 53248
    s_add_u32 s56, s34, 2162688
    buffer_load_dwordx4 v44, s[12:15], s56 offen lds
    buffer_load_dwordx4 v44, s[12:15], s56 offen offset:1024 lds
    buffer_load_dwordx4 v44, s[12:15], s56 offen offset:2048 lds
    buffer_load_dwordx4 v44, s[12:15], s56 offen offset:3072 lds
    s_mov_b32 m0, 67584
    s_mov_b32 s56, 122880
    buffer_load_dwordx4 v46, s[16:19], s56 offen lds
    s_mov_b32 m0, 68608
    s_mov_b32 s56, 148480
    buffer_load_dwordx4 v46, s[16:19], s56 offen lds
    s_waitcnt vmcnt(18)
    s_barrier
    s_mov_b32 m0, 77824
    s_add_u32 s56, s34, 2424832
    buffer_load_dwordx4 v44, s[12:15], s56 offen lds
    buffer_load_dwordx4 v44, s[12:15], s56 offen offset:1024 lds
    buffer_load_dwordx4 v44, s[12:15], s56 offen offset:2048 lds
    buffer_load_dwordx4 v44, s[12:15], s56 offen offset:3072 lds
    s_mov_b32 m0, 92160
    s_mov_b32 s56, 532480
    buffer_load_dwordx4 v46, s[16:19], s56 offen lds
    s_mov_b32 m0, 93184
    s_mov_b32 s56, 558080
    buffer_load_dwordx4 v46, s[16:19], s56 offen lds
    s_waitcnt vmcnt(18)
    s_barrier
    s_waitcnt vmcnt(12)
    s_barrier
    s_waitcnt vmcnt(6)
    s_barrier
    s_waitcnt vmcnt(0)
    s_barrier
    s_waitcnt vmcnt(0)
    s_barrier
    s_branch k3_end
k3_ld2:
    s_mov_b32 m0, 8192
    s_add_u32 s56, s34, 131072
    buffer_load_dwordx4 v44, s[12:15], s56 offen lds
    buffer_load_dwordx4 v44, s[12:15], s56 offen offset:1024 lds
    buffer_load_dwordx4 v44, s[12:15], s56 offen offset:2048 lds
    buffer_load_dwordx4 v44, s[12:15], s56 offen offset:3072 lds
    s_mov_b32 m0, 20480
    s_mov_b32 s56, 51200
    buffer_load_dwordx4 v45, s[16:19], s56 offen lds
    s_mov_b32 m0, 21504
    s_mov_b32 s56, 61440
    buffer_load_dwordx4 v45, s[16:19], s56 offen lds
    s_mov_b32 m0, 32768
    s_add_u32 s56, s34, 393216
    buffer_load_dwordx4 v44, s[12:15], s56 offen lds
    buffer_load_dwordx4 v44, s[12:15], s56 offen offset:1024 lds
    buffer_load_dwordx4 v44, s[12:15], s56 offen offset:2048 lds
    buffer_load_dwordx4 v44, s[12:15], s56 offen offset:3072 lds
    s_mov_b32 m0, 45056
    s_mov_b32 s56, 153600
    buffer_load_dwordx4 v45, s[16:19], s56 offen lds
    s_mov_b32 m0, 46080
    s_mov_b32 s56, 163840
    buffer_load_dwordx4 v45, s[16:19], s56 offen lds
    s_waitcnt vmcnt(6)
    s_barrier
    s_mov_b32 m0, 57344
    s_add_u32 s56, s34, 655360
    buffer_load_dwordx4 v44, s[12:15], s56 offen lds
    buffer_load_dwordx4 v44, s[12:15], s56 offen offset:1024 lds
    buffer_load_dwordx4 v44, s[12:15], s56 offen offset:2048 lds
    buffer_load_dwordx4 v44, s[12:15], s56 offen offset:3072 lds
    s_mov_b32 m0, 69632
    s_mov_b32 s56, 256000
    buffer_load_dwordx4 v45, s[16:19], s56 offen lds
    s_mov_b32 m0, 70656
    s_mov_b32 s56, 266240
    buffer_load_dwordx4 v45, s[16:19], s56 offen lds
    s_mov_b32 m0, 81920
    s_add_u32 s56, s34, 917504
    buffer_load_dwordx4 v44, s[12:15], s56 offen lds
    buffer_load_dwordx4 v44, s[12:15], s56 offen offset:1024 lds
    buffer_load_dwordx4 v44, s[12:15], s56 offen offset:2048 lds
    buffer_load_dwordx4 v44, s[12:15], s56 offen offset:3072 lds
    s_mov_b32 m0, 94208
    s_mov_b32 s56, 358400
    buffer_load_dwordx4 v45, s[16:19], s56 offen lds
    s_mov_b32 m0, 95232
    s_mov_b32 s56, 368640
    buffer_load_dwordx4 v45, s[16:19], s56 offen lds
    s_mov_b32 m0, 106496
    s_add_u32 s56, s34, 1179648
    buffer_load_dwordx4 v44, s[12:15], s56 offen lds
    buffer_load_dwordx4 v44, s[12:15], s56 offen offset:1024 lds
    buffer_load_dwordx4 v44, s[12:15], s56 offen offset:2048 lds
    buffer_load_dwordx4 v44, s[12:15], s56 offen offset:3072 lds
    s_mov_b32 m0, 118784
    s_mov_b32 s56, 460800
    buffer_load_dwordx4 v45, s[16:19], s56 offen lds
    s_mov_b32 m0, 119808
    s_mov_b32 s56, 471040
    buffer_load_dwordx4 v45, s[16:19], s56 offen lds
    s_waitcnt vmcnt(18)
    s_barrier
    s_mov_b32 m0, 131072
    s_add_u32 s56, s34, 1441792
    buffer_load_dwordx4 v44, s[12:15], s56 offen lds
    buffer_load_dwordx4 v44, s[12:15], s56 offen offset:1024 lds
    buffer_load_dwordx4 v44, s[12:15], s56 offen offset:2048 lds
    buffer_load_dwordx4 v44, s[12:15], s56 offen offset:3072 lds
    s_mov_b32 m0, 143360
    s_mov_b32 s56, 563200
    buffer_load_dwordx4 v45, s[16:19], s56 offen lds
    s_mov_b32 m0, 144384
    s_mov_b32 s56, 573440
    buffer_load_dwordx4 v45, s[16:19], s56 offen lds
    s_waitcnt vmcnt(18)
    s_barrier
    s_mov_b32 m0, 8192
    s_add_u32 s56, s34, 1703936
    buffer_load_dwordx4 v44, s[12:15], s56 offen lds
    buffer_load_dwordx4 v44, s[12:15], s56 offen offset:1024 lds
    buffer_load_dwordx4 v44, s[12:15], s56 offen offset:2048 lds
    buffer_load_dwordx4 v44, s[12:15], s56 offen offset:3072 lds
    s_mov_b32 m0, 20480
    s_mov_b32 s56, 665600
    buffer_load_dwordx4 v45, s[16:19], s56 offen lds
    s_mov_b32 m0, 21504
    s_mov_b32 s56, 675840
    buffer_load_dwordx4 v45, s[16:19], s56 offen lds
    s_waitcnt vmcnt(18)
    s_barrier
    s_mov_b32 m0, 32768
    s_add_u32 s56, s34, 1966080
    buffer_load_dwordx4 v44, s[12:15], s56 offen lds
    buffer_load_dwordx4 v44, s[12:15], s56 offen offset:1024 lds
    buffer_load_dwordx4 v44, s[12:15], s56 offen offset:2048 lds
    buffer_load_dwordx4 v44, s[12:15], s56 offen offset:3072 lds
    s_mov_b32 m0, 45056
    s_mov_b32 s56, 768000
    buffer_load_dwordx4 v45, s[16:19], s56 offen lds
    s_mov_b32 m0, 46080
    s_mov_b32 s56, 778240
    buffer_load_dwordx4 v45, s[16:19], s56 offen lds
    s_waitcnt vmcnt(18)
    s_barrier
    s_mov_b32 m0, 57344
    s_add_u32 s56, s34, 2228224
    buffer_load_dwordx4 v44, s[12:15], s56 offen lds
    buffer_load_dwordx4 v44, s[12:15], s56 offen offset:1024 lds
    buffer_load_dwordx4 v44, s[12:15], s56 offen offset:2048 lds
    buffer_load_dwordx4 v44, s[12:15], s56 offen offset:3072 lds
    s_mov_b32 m0, 69632
    s_mov_b32 s56, 225280
    buffer_load_dwordx4 v46, s[16:19], s56 offen lds
    s_mov_b32 m0, 70656
    s_mov_b32 s56, 250880
    buffer_load_dwordx4 v46, s[16:19], s56 offen lds
    s_waitcnt vmcnt(18)
    s_barrier
    s_mov_b32 m0, 81920
    s_add_u32 s56, s34, 2490368
    buffer_load_dwordx4 v44, s[12:15], s56 offen lds
    buffer_load_dwordx4 v44, s[12:15], s56 offen offset:1024 lds
    buffer_load_dwordx4 v44, s[12:15], s56 offen offset:2048 lds
    buffer_load_dwordx4 v44, s[12:15], s56 offen offset:3072 lds
    s_mov_b32 m0, 94208
    s_mov_b32 s56, 634880
    buffer_load_dwordx4 v46, s[16:19], s56 offen lds
    s_mov_b32 m0, 95232
    s_mov_b32 s56, 660480
    buffer_load_dwordx4 v46, s[16:19], s56 offen lds
    s_waitcnt vmcnt(18)
    s_barrier
    s_waitcnt vmcnt(12)
    s_barrier
    s_waitcnt vmcnt(6)
    s_barrier
    s_waitcnt vmcnt(0)
    s_barrier
    s_waitcnt vmcnt(0)
    s_barrier
    s_branch k3_end
k3_ld3:
    s_mov_b32 m0, 12288
    s_add_u32 s56, s34, 196608
    buffer_load_dwordx4 v44, s[12:15], s56 offen lds
    buffer_load_dwordx4 v44, s[12:15], s56 offen offset:1024 lds
    buffer_load_dwordx4 v44, s[12:15], s56 offen offset:2048 lds
    buffer_load_dwordx4 v44, s[12:15], s56 offen offset:3072 lds
    s_mov_b32 m0, 22528
    s_mov_b32 s56, 76800
    buffer_load_dwordx4 v45, s[16:19], s56 offen lds
    s_mov_b32 m0, 23552
    s_mov_b32 s56, 87040
    buffer_load_dwordx4 v45, s[16:19], s56 offen lds
    s_mov_b32 m0, 36864
    s_add_u32 s56, s34, 458752
    buffer_load_dwordx4 v44, s[12:15], s56 offen lds
    buffer_load_dwordx4 v44, s[12:15], s56 offen offset:1024 lds
    buffer_load_dwordx4 v44, s[12:15], s56 offen offset:2048 lds
    buffer_load_dwordx4 v44, s[12:15], s56 offen offset:3072 lds
    s_mov_b32 m0, 47104
    s_mov_b32 s56, 179200
    buffer_load_dwordx4 v45, s[16:19], s56 offen lds
    s_mov_b32 m0, 48128
    s_mov_b32 s56, 189440
    buffer_load_dwordx4 v45, s[16:19], s56 offen lds
    s_waitcnt vmcnt(6)
    s_barrier
    s_mov_b32 m0, 61440
    s_add_u32 s56, s34, 720896
    buffer_load_dwordx4 v44, s[12:15], s56 offen lds
    buffer_load_dwordx4 v44, s[12:15], s56 offen offset:1024 lds
    buffer_load_dwordx4 v44, s[12:15], s56 offen offset:2048 lds
    buffer_load_dwordx4 v44, s[12:15], s56 offen offset:3072 lds
    s_mov_b32 m0, 71680
    s_mov_b32 s56, 281600
    buffer_load_dwordx4 v45, s[16:19], s56 offen lds
    s_mov_b32 m0, 72704
    s_mov_b32 s56, 291840
    buffer_load_dwordx4 v45, s[16:19], s56 offen lds
    s_mov_b32 m0, 86016
    s_add_u32 s56, s34, 983040
    buffer_load_dwordx4 v44, s[12:15], s56 offen lds
    buffer_load_dwordx4 v44, s[12:15], s56 offen offset:1024 lds
    buffer_load_dwordx4 v44, s[12:15], s56 offen offset:2048 lds
    buffer_load_dwordx4 v44, s[12:15], s56 offen offset:3072 lds
    s_mov_b32 m0, 96256
    s_mov_b32 s56, 384000
    buffer_load_dwordx4 v45, s[16:19], s56 offen lds
    s_mov_b32 m0, 97280
    s_mov_b32 s56, 394240
    buffer_load_dwordx4 v45, s[16:19], s56 offen lds
    s_mov_b32 m0, 110592
    s_add_u32 s56, s34, 1245184
    buffer_load_dwordx4 v44, s[12:15], s56 offen lds
    buffer_load_dwordx4 v44, s[12:15], s56 offen offset:1024 lds
    buffer_load_dwordx4 v44, s[12:15], s56 offen offset:2048 lds
    buffer_load_dwordx4 v44, s[12:15], s56 offen offset:3072 lds
    s_mov_b32 m0, 120832
    s_mov_b32 s56, 486400
    buffer_load_dwordx4 v45, s[16:19], s56 offen lds
    s_mov_b32 m0, 121856
    s_mov_b32 s56, 496640
    buffer_load_dwordx4 v45, s[16:19], s56 offen lds
    s_waitcnt vmcnt(18)
    s_barrier
    s_mov_b32 m0, 135168
    s_add_u32 s56, s34, 1507328
    buffer_load_dwordx4 v44, s[12:15], s56 offen lds
    buffer_load_dwordx4 v44, s[12:15], s56 offen offset:1024 lds
    buffer_load_dwordx4 v44, s[12:15], s56 offen offset:2048 lds
    buffer_load_dwordx4 v44, s[12:15], s56 offen offset:3072 lds
    s_mov_b32 m0, 145408
    s_mov_b32 s56, 588800
    buffer_load_dwordx4 v45, s[16:19], s56 offen lds
    s_mov_b32 m0, 146432
    s_mov_b32 s56, 599040
    buffer_load_dwordx4 v45, s[16:19], s56 offen lds
    s_waitcnt vmcnt(18)
    s_barrier
    s_mov_b32 m0, 12288
    s_add_u32 s56, s34, 1769472
    buffer_load_dwordx4 v44, s[12:15], s56 offen lds
    buffer_load_dwordx4 v44, s[12:15], s56 offen offset:1024 lds
    buffer_load_dwordx4 v44, s[12:15], s56 offen offset:2048 lds
    buffer_load_dwordx4 v44, s[12:15], s56 offen offset:3072 lds
    s_mov_b32 m0, 22528
    s_mov_b32 s56, 691200
    buffer_load_dwordx4 v45, s[16:19], s56 offen lds
    s_mov_b32 m0, 23552
    s_mov_b32 s56, 701440
    buffer_load_dwordx4 v45, s[16:19], s56 offen lds
    s_waitcnt vmcnt(18)
    s_barrier
    s_mov_b32 m0, 36864
    s_add_u32 s56, s34, 2031616
    buffer_load_dwordx4 v44, s[12:15], s56 offen lds
    buffer_load_dwordx4 v44, s[12:15], s56 offen offset:1024 lds
    buffer_load_dwordx4 v44, s[12:15], s56 offen offset:2048 lds
    buffer_load_dwordx4 v44, s[12:15], s56 offen offset:3072 lds
    s_mov_b32 m0, 47104
    s_mov_b32 s56, 793600
    buffer_load_dwordx4 v45, s[16:19], s56 offen lds
    s_mov_b32 m0, 48128
    s_mov_b32 s56, 803840
    buffer_load_dwordx4 v45, s[16:19], s56 offen lds
    s_waitcnt vmcnt(18)
    s_barrier
    s_mov_b32 m0, 61440
    s_add_u32 s56, s34, 2293760
    buffer_load_dwordx4 v44, s[12:15], s56 offen lds
    buffer_load_dwordx4 v44, s[12:15], s56 offen offset:1024 lds
    buffer_load_dwordx4 v44, s[12:15], s56 offen offset:2048 lds
    buffer_load_dwordx4 v44, s[12:15], s56 offen offset:3072 lds
    s_mov_b32 m0, 71680
    s_mov_b32 s56, 327680
    buffer_load_dwordx4 v46, s[16:19], s56 offen lds
    s_mov_b32 m0, 72704
    s_mov_b32 s56, 353280
    buffer_load_dwordx4 v46, s[16:19], s56 offen lds
    s_waitcnt vmcnt(18)
    s_barrier
    s_mov_b32 m0, 86016
    s_add_u32 s56, s34, 2555904
    buffer_load_dwordx4 v44, s[12:15], s56 offen lds
    buffer_load_dwordx4 v44, s[12:15], s56 offen offset:1024 lds
    buffer_load_dwordx4 v44, s[12:15], s56 offen offset:2048 lds
    buffer_load_dwordx4 v44, s[12:15], s56 offen offset:3072 lds
    s_mov_b32 m0, 96256
    s_mov_b32 s56, 737280
    buffer_load_dwordx4 v46, s[16:19], s56 offen lds
    s_mov_b32 m0, 97280
    s_mov_b32 s56, 762880
    buffer_load_dwordx4 v46, s[16:19], s56 offen lds
    s_waitcnt vmcnt(18)
    s_barrier
    s_waitcnt vmcnt(12)
    s_barrier
    s_waitcnt vmcnt(6)
    s_barrier
    s_waitcnt vmcnt(0)
    s_barrier
    s_waitcnt vmcnt(0)
    s_barrier
    s_branch k3_end
k3_c:
    s_mov_b32 s12, s8
    s_and_b32 s13, s9, 0xffff
    s_mov_b32 s14, 2621440
    s_mov_b32 s15, 0x00020000
    s_mov_b32 s32, s10
    s_and_b32 s33, s11, 0xffff
    s_mov_b32 s34, 2621440
    s_mov_b32 s35, 0x00020000
    s_lshr_b32 s56, s24, 1
    s_and_b32 s57, s24, 1
    v_lshlrev_b32 v44, 4, v0
    s_mul_i32 s56, s56, 1024
    s_add_u32 s56, s56, 0
    v_add_u32 v40, s56, v44
    v_bfe_u32 v47, v0, 2, 2
    v_lshrrev_b32 v48, 5, v0
    v_mad_u32_u24 v48, v48, 4, v47
    v_mul_u32_u24 v48, 128, v48
    v_bfe_u32 v49, v0, 4, 1
    v_lshl_add_u32 v48, v49, 5, v48
    v_and_b32 v49, 3, v0
    v_lshl_add_u32 v48, v49, 3, v48
    v_add_u32 v48, 16384, v48
    v_lshrrev_b32 v47, 1, v47
    s_mul_i32 s56, s57, 1
    s_add_u32 s56, s56, 0
    v_xor_b32 v49, s56, v47
    v_lshl_add_u32 v41, v49, 6, v48
    s_mov_b32 s48, 0
    s_lshr_b32 s60, s24, 1
    s_and_b32 s61, s24, 1
    s_lshl_b32 s62, s23, 2
    s_add_u32 s62, s62, s60
    s_mul_i32 s63, s62, 20
    s_lshl_b32 s64, s25, 1
    s_add_u32 s63, s63, s64
    s_add_u32 s63, s63, s61
    s_lshl_b32 s63, s63, 11
    s_add_u32 s63, s63, 22806528
    s_add_u32 s64, s63, 40960
    v_and_b32 v72, 31, v0
    v_mul_u32_u24 v68, 1280, v72
    v_lshrrev_b32 v73, 5, v0
    v_lshl_add_u32 v68, v73, 4, v68
    s_mul_i32 s65, s62, 40960
    s_add_u32 s65, s65, s28
    s_lshl_b32 s66, s61, 6
    s_add_u32 s65, s65, s66
    s_add_u32 s66, s65, 40960
    v_mov_b32 v8, 0
    v_mov_b32 v9, 0
    v_mov_b32 v10, 0
    v_mov_b32 v11, 0
    v_mov_b32 v12, 0
    v_mov_b32 v13, 0
    v_mov_b32 v14, 0
    v_mov_b32 v15, 0
    v_mov_b32 v16, 0
    v_mov_b32 v17, 0
    v_mov_b32 v18, 0
    v_mov_b32 v19, 0
    v_mov_b32 v20, 0
    v_mov_b32 v21, 0
    v_mov_b32 v22, 0
    v_mov_b32 v23, 0
    v_add_u32 v42, s48, v40
    v_add_u32 v43, s48, v41
    s_barrier
    ds_read_b128 v[96:99], v42 offset:0
    ds_read_b64_tr_b16 v[100:101], v43 offset:0
    ds_read_b64_tr_b16 v[102:103], v43 offset:1024
    ds_read_b128 v[104:107], v42 offset:4096
    ds_read_b64_tr_b16 v[108:109], v43 offset:2048
    ds_read_b64_tr_b16 v[110:111], v43 offset:3072
    ds_read_b128 v[112:115], v42 offset:8192
    ds_read_b64_tr_b16 v[116:117], v43 offset:4096
    ds_read_b64_tr_b16 v[118:119], v43 offset:5120
    ds_read_b128 v[120:123], v42 offset:12288
    ds_read_b64_tr_b16 v[124:125], v43 offset:6144
    ds_read_b64_tr_b16 v[126:127], v43 offset:7168
    buffer_load_dwordx4 v[52:55], v44, s[36:39], s63 offen offset:0
    buffer_load_dwordx4 v[56:59], v44, s[36:39], s63 offen offset:1024
    buffer_load_dwordx4 v[60:63], v68, s[12:15], s65 offen offset:0
    buffer_load_dwordx4 v[64:67], v68, s[12:15], s65 offen offset:32
    s_barrier
    s_mov_b32 s48, 24576
    v_add_u32 v42, s48, v40
    v_add_u32 v43, s48, v41
    ds_read_b128 v[128:131], v42 offset:0
    ds_read_b64_tr_b16 v[132:133], v43 offset:0
    ds_read_b64_tr_b16 v[134:135], v43 offset:1024
    ds_read_b128 v[136:139], v42 offset:4096
    ds_read_b64_tr_b16 v[140:141], v43 offset:2048
    ds_read_b64_tr_b16 v[142:143], v43 offset:3072
    ds_read_b128 v[144:147], v42 offset:8192
    ds_read_b64_tr_b16 v[148:149], v43 offset:4096
    ds_read_b64_tr_b16 v[150:151], v43 offset:5120
    ds_read_b128 v[152:155], v42 offset:12288
    ds_read_b64_tr_b16 v[156:157], v43 offset:6144
    ds_read_b64_tr_b16 v[158:159], v43 offset:7168
    s_waitcnt lgkmcnt(12)
    v_mfma_f32_32x32x16_bf16 v[8:23], v[100:103], v[96:99], v[8:23]
    v_mfma_f32_32x32x16_bf16 v[8:23], v[108:111], v[104:107], v[8:23]
    v_mfma_f32_32x32x16_bf16 v[8:23], v[116:119], v[112:115], v[8:23]
    v_mfma_f32_32x32x16_bf16 v[8:23], v[124:127], v[120:123], v[8:23]
    s_barrier
    s_mov_b32 s48, 49152
    v_add_u32 v42, s48, v40
    v_add_u32 v43, s48, v41
    ds_read_b128 v[96:99], v42 offset:0
    ds_read_b64_tr_b16 v[100:101], v43 offset:0
    ds_read_b64_tr_b16 v[102:103], v43 offset:1024
    ds_read_b128 v[104:107], v42 offset:4096
    ds_read_b64_tr_b16 v[108:109], v43 offset:2048
    ds_read_b64_tr_b16 v[110:111], v43 offset:3072
    ds_read_b128 v[112:115], v42 offset:8192
    ds_read_b64_tr_b16 v[116:117], v43 offset:4096
    ds_read_b64_tr_b16 v[118:119], v43 offset:5120
    ds_read_b128 v[120:123], v42 offset:12288
    ds_read_b64_tr_b16 v[124:125], v43 offset:6144
    ds_read_b64_tr_b16 v[126:127], v43 offset:7168
    s_waitcnt lgkmcnt(12)
    v_mfma_f32_32x32x16_bf16 v[8:23], v[132:135], v[128:131], v[8:23]
    v_mfma_f32_32x32x16_bf16 v[8:23], v[140:143], v[136:139], v[8:23]
    v_mfma_f32_32x32x16_bf16 v[8:23], v[148:151], v[144:147], v[8:23]
    v_mfma_f32_32x32x16_bf16 v[8:23], v[156:159], v[152:155], v[8:23]
    s_barrier
    s_mov_b32 s48, 73728
    v_add_u32 v42, s48, v40
    v_add_u32 v43, s48, v41
    ds_read_b128 v[128:131], v42 offset:0
    ds_read_b64_tr_b16 v[132:133], v43 offset:0
    ds_read_b64_tr_b16 v[134:135], v43 offset:1024
    ds_read_b128 v[136:139], v42 offset:4096
    ds_read_b64_tr_b16 v[140:141], v43 offset:2048
    ds_read_b64_tr_b16 v[142:143], v43 offset:3072
    ds_read_b128 v[144:147], v42 offset:8192
    ds_read_b64_tr_b16 v[148:149], v43 offset:4096
    ds_read_b64_tr_b16 v[150:151], v43 offset:5120
    ds_read_b128 v[152:155], v42 offset:12288
    ds_read_b64_tr_b16 v[156:157], v43 offset:6144
    ds_read_b64_tr_b16 v[158:159], v43 offset:7168
    s_waitcnt lgkmcnt(12)
    v_mfma_f32_32x32x16_bf16 v[8:23], v[100:103], v[96:99], v[8:23]
    v_mfma_f32_32x32x16_bf16 v[8:23], v[108:111], v[104:107], v[8:23]
    v_mfma_f32_32x32x16_bf16 v[8:23], v[116:119], v[112:115], v[8:23]
    v_mfma_f32_32x32x16_bf16 v[8:23], v[124:127], v[120:123], v[8:23]
    s_barrier
    s_mov_b32 s48, 98304
    v_add_u32 v42, s48, v40
    v_add_u32 v43, s48, v41
    ds_read_b128 v[96:99], v42 offset:0
    ds_read_b64_tr_b16 v[100:101], v43 offset:0
    ds_read_b64_tr_b16 v[102:103], v43 offset:1024
    ds_read_b128 v[104:107], v42 offset:4096
    ds_read_b64_tr_b16 v[108:109], v43 offset:2048
    ds_read_b64_tr_b16 v[110:111], v43 offset:3072
    ds_read_b128 v[112:115], v42 offset:8192
    ds_read_b64_tr_b16 v[116:117], v43 offset:4096
    ds_read_b64_tr_b16 v[118:119], v43 offset:5120
    ds_read_b128 v[120:123], v42 offset:12288
    ds_read_b64_tr_b16 v[124:125], v43 offset:6144
    ds_read_b64_tr_b16 v[126:127], v43 offset:7168
    s_waitcnt lgkmcnt(12)
    v_mfma_f32_32x32x16_bf16 v[8:23], v[132:135], v[128:131], v[8:23]
    v_mfma_f32_32x32x16_bf16 v[8:23], v[140:143], v[136:139], v[8:23]
    v_mfma_f32_32x32x16_bf16 v[8:23], v[148:151], v[144:147], v[8:23]
    v_mfma_f32_32x32x16_bf16 v[8:23], v[156:159], v[152:155], v[8:23]
    s_barrier
    s_mov_b32 s48, 122880
    v_add_u32 v42, s48, v40
    v_add_u32 v43, s48, v41
    ds_read_b128 v[128:131], v42 offset:0
    ds_read_b64_tr_b16 v[132:133], v43 offset:0
    ds_read_b64_tr_b16 v[134:135], v43 offset:1024
    ds_read_b128 v[136:139], v42 offset:4096
    ds_read_b64_tr_b16 v[140:141], v43 offset:2048
    ds_read_b64_tr_b16 v[142:143], v43 offset:3072
    ds_read_b128 v[144:147], v42 offset:8192
    ds_read_b64_tr_b16 v[148:149], v43 offset:4096
    ds_read_b64_tr_b16 v[150:151], v43 offset:5120
    ds_read_b128 v[152:155], v42 offset:12288
    ds_read_b64_tr_b16 v[156:157], v43 offset:6144
    ds_read_b64_tr_b16 v[158:159], v43 offset:7168
    s_waitcnt lgkmcnt(12)
    v_mfma_f32_32x32x16_bf16 v[8:23], v[100:103], v[96:99], v[8:23]
    v_mfma_f32_32x32x16_bf16 v[8:23], v[108:111], v[104:107], v[8:23]
    v_mfma_f32_32x32x16_bf16 v[8:23], v[116:119], v[112:115], v[8:23]
    v_mfma_f32_32x32x16_bf16 v[8:23], v[124:127], v[120:123], v[8:23]
    s_barrier
    s_mov_b32 s48, 0
    v_add_u32 v42, s48, v40
    v_add_u32 v43, s48, v41
    ds_read_b128 v[96:99], v42 offset:0
    ds_read_b64_tr_b16 v[100:101], v43 offset:0
    ds_read_b64_tr_b16 v[102:103], v43 offset:1024
    ds_read_b128 v[104:107], v42 offset:4096
    ds_read_b64_tr_b16 v[108:109], v43 offset:2048
    ds_read_b64_tr_b16 v[110:111], v43 offset:3072
    ds_read_b128 v[112:115], v42 offset:8192
    ds_read_b64_tr_b16 v[116:117], v43 offset:4096
    ds_read_b64_tr_b16 v[118:119], v43 offset:5120
    ds_read_b128 v[120:123], v42 offset:12288
    ds_read_b64_tr_b16 v[124:125], v43 offset:6144
    ds_read_b64_tr_b16 v[126:127], v43 offset:7168
    s_waitcnt lgkmcnt(12)
    v_mfma_f32_32x32x16_bf16 v[8:23], v[132:135], v[128:131], v[8:23]
    v_mfma_f32_32x32x16_bf16 v[8:23], v[140:143], v[136:139], v[8:23]
    v_mfma_f32_32x32x16_bf16 v[8:23], v[148:151], v[144:147], v[8:23]
    v_mfma_f32_32x32x16_bf16 v[8:23], v[156:159], v[152:155], v[8:23]
    s_barrier
    s_mov_b32 s48, 24576
    v_add_u32 v42, s48, v40
    v_add_u32 v43, s48, v41
    ds_read_b128 v[128:131], v42 offset:0
    ds_read_b64_tr_b16 v[132:133], v43 offset:0
    ds_read_b64_tr_b16 v[134:135], v43 offset:1024
    ds_read_b128 v[136:139], v42 offset:4096
    ds_read_b64_tr_b16 v[140:141], v43 offset:2048
    ds_read_b64_tr_b16 v[142:143], v43 offset:3072
    ds_read_b128 v[144:147], v42 offset:8192
    ds_read_b64_tr_b16 v[148:149], v43 offset:4096
    ds_read_b64_tr_b16 v[150:151], v43 offset:5120
    ds_read_b128 v[152:155], v42 offset:12288
    ds_read_b64_tr_b16 v[156:157], v43 offset:6144
    ds_read_b64_tr_b16 v[158:159], v43 offset:7168
    s_waitcnt lgkmcnt(12)
    v_mfma_f32_32x32x16_bf16 v[8:23], v[100:103], v[96:99], v[8:23]
    v_mfma_f32_32x32x16_bf16 v[8:23], v[108:111], v[104:107], v[8:23]
    v_mfma_f32_32x32x16_bf16 v[8:23], v[116:119], v[112:115], v[8:23]
    v_mfma_f32_32x32x16_bf16 v[8:23], v[124:127], v[120:123], v[8:23]
    s_barrier
    s_mov_b32 s48, 49152
    v_add_u32 v42, s48, v40
    v_add_u32 v43, s48, v41
    ds_read_b128 v[96:99], v42 offset:0
    ds_read_b64_tr_b16 v[100:101], v43 offset:0
    ds_read_b64_tr_b16 v[102:103], v43 offset:1024
    ds_read_b128 v[104:107], v42 offset:4096
    ds_read_b64_tr_b16 v[108:109], v43 offset:2048
    ds_read_b64_tr_b16 v[110:111], v43 offset:3072
    ds_read_b128 v[112:115], v42 offset:8192
    ds_read_b64_tr_b16 v[116:117], v43 offset:4096
    ds_read_b64_tr_b16 v[118:119], v43 offset:5120
    ds_read_b128 v[120:123], v42 offset:12288
    ds_read_b64_tr_b16 v[124:125], v43 offset:6144
    ds_read_b64_tr_b16 v[126:127], v43 offset:7168
    s_waitcnt lgkmcnt(12)
    v_mfma_f32_32x32x16_bf16 v[8:23], v[132:135], v[128:131], v[8:23]
    v_mfma_f32_32x32x16_bf16 v[8:23], v[140:143], v[136:139], v[8:23]
    v_mfma_f32_32x32x16_bf16 v[8:23], v[148:151], v[144:147], v[8:23]
    v_mfma_f32_32x32x16_bf16 v[8:23], v[156:159], v[152:155], v[8:23]
    s_barrier
    s_mov_b32 s48, 73728
    v_add_u32 v42, s48, v40
    v_add_u32 v43, s48, v41
    ds_read_b128 v[128:131], v42 offset:0
    ds_read_b64_tr_b16 v[132:133], v43 offset:0
    ds_read_b64_tr_b16 v[134:135], v43 offset:1024
    ds_read_b128 v[136:139], v42 offset:4096
    ds_read_b64_tr_b16 v[140:141], v43 offset:2048
    ds_read_b64_tr_b16 v[142:143], v43 offset:3072
    ds_read_b128 v[144:147], v42 offset:8192
    ds_read_b64_tr_b16 v[148:149], v43 offset:4096
    ds_read_b64_tr_b16 v[150:151], v43 offset:5120
    ds_read_b128 v[152:155], v42 offset:12288
    ds_read_b64_tr_b16 v[156:157], v43 offset:6144
    ds_read_b64_tr_b16 v[158:159], v43 offset:7168
    s_waitcnt lgkmcnt(12)
    v_mfma_f32_32x32x16_bf16 v[8:23], v[100:103], v[96:99], v[8:23]
    v_mfma_f32_32x32x16_bf16 v[8:23], v[108:111], v[104:107], v[8:23]
    v_mfma_f32_32x32x16_bf16 v[8:23], v[116:119], v[112:115], v[8:23]
    v_mfma_f32_32x32x16_bf16 v[8:23], v[124:127], v[120:123], v[8:23]
    s_barrier
    s_waitcnt lgkmcnt(0)
    v_mfma_f32_32x32x16_bf16 v[8:23], v[132:135], v[128:131], v[8:23]
    v_mfma_f32_32x32x16_bf16 v[8:23], v[140:143], v[136:139], v[8:23]
    v_mfma_f32_32x32x16_bf16 v[8:23], v[148:151], v[144:147], v[8:23]
    v_mfma_f32_32x32x16_bf16 v[8:23], v[156:159], v[152:155], v[8:23]
    s_nop 15
    s_waitcnt vmcnt(0)
    v_permlane32_swap_b32 v60, v62
    v_permlane32_swap_b32 v61, v63
    v_permlane32_swap_b32 v64, v66
    v_permlane32_swap_b32 v65, v67
    v_cvt_pk_bf16_f32 v80, v8, v9
    v_cvt_pk_bf16_f32 v81, v10, v11
    v_lshlrev_b32 v82, 16, v80
    v_and_b32 v83, 0xffff0000, v80
    v_lshlrev_b32 v86, 16, v52
    v_and_b32 v87, 0xffff0000, v52
    v_lshlrev_b32 v84, 16, v81
    v_and_b32 v85, 0xffff0000, v81
    v_lshlrev_b32 v88, 16, v53
    v_and_b32 v89, 0xffff0000, v53
    v_mul_f32 v82, v82, v86
    v_mul_f32 v83, v83, v87
    v_mul_f32 v84, v84, v88
    v_mul_f32 v85, v85, v89
    v_cvt_pk_bf16_f32 v80, v82, v83
    v_cvt_pk_bf16_f32 v81, v84, v85
    v_lshlrev_b32 v82, 16, v80
    v_and_b32 v83, 0xffff0000, v80
    v_lshlrev_b32 v86, 16, v60
    v_and_b32 v87, 0xffff0000, v60
    v_lshlrev_b32 v84, 16, v81
    v_and_b32 v85, 0xffff0000, v81
    v_lshlrev_b32 v88, 16, v61
    v_and_b32 v89, 0xffff0000, v61
    v_add_f32 v82, v82, v86
    v_add_f32 v83, v83, v87
    v_add_f32 v84, v84, v88
    v_add_f32 v85, v85, v89
    v_cvt_pk_bf16_f32 v72, v82, v83
    v_cvt_pk_bf16_f32 v73, v84, v85
    v_cvt_pk_bf16_f32 v80, v12, v13
    v_cvt_pk_bf16_f32 v81, v14, v15
    v_lshlrev_b32 v82, 16, v80
    v_and_b32 v83, 0xffff0000, v80
    v_lshlrev_b32 v86, 16, v54
    v_and_b32 v87, 0xffff0000, v54
    v_lshlrev_b32 v84, 16, v81
    v_and_b32 v85, 0xffff0000, v81
    v_lshlrev_b32 v88, 16, v55
    v_and_b32 v89, 0xffff0000, v55
    v_mul_f32 v82, v82, v86
    v_mul_f32 v83, v83, v87
    v_mul_f32 v84, v84, v88
    v_mul_f32 v85, v85, v89
    v_cvt_pk_bf16_f32 v80, v82, v83
    v_cvt_pk_bf16_f32 v81, v84, v85
    v_lshlrev_b32 v82, 16, v80
    v_and_b32 v83, 0xffff0000, v80
    v_lshlrev_b32 v86, 16, v62
    v_and_b32 v87, 0xffff0000, v62
    v_lshlrev_b32 v84, 16, v81
    v_and_b32 v85, 0xffff0000, v81
    v_lshlrev_b32 v88, 16, v63
    v_and_b32 v89, 0xffff0000, v63
    v_add_f32 v82, v82, v86
    v_add_f32 v83, v83, v87
    v_add_f32 v84, v84, v88
    v_add_f32 v85, v85, v89
    v_cvt_pk_bf16_f32 v74, v82, v83
    v_cvt_pk_bf16_f32 v75, v84, v85
    s_nop 1
    v_permlane32_swap_b32 v72, v74
    v_permlane32_swap_b32 v73, v75
    buffer_store_dwordx4 v[72:75], v68, s[32:35], s65 offen offset:0
    v_cvt_pk_bf16_f32 v80, v16, v17
    v_cvt_pk_bf16_f32 v81, v18, v19
    v_lshlrev_b32 v82, 16, v80
    v_and_b32 v83, 0xffff0000, v80
    v_lshlrev_b32 v86, 16, v56
    v_and_b32 v87, 0xffff0000, v56
    v_lshlrev_b32 v84, 16, v81
    v_and_b32 v85, 0xffff0000, v81
    v_lshlrev_b32 v88, 16, v57
    v_and_b32 v89, 0xffff0000, v57
    v_mul_f32 v82, v82, v86
    v_mul_f32 v83, v83, v87
    v_mul_f32 v84, v84, v88
    v_mul_f32 v85, v85, v89
    v_cvt_pk_bf16_f32 v80, v82, v83
    v_cvt_pk_bf16_f32 v81, v84, v85
    v_lshlrev_b32 v82, 16, v80
    v_and_b32 v83, 0xffff0000, v80
    v_lshlrev_b32 v86, 16, v64
    v_and_b32 v87, 0xffff0000, v64
    v_lshlrev_b32 v84, 16, v81
    v_and_b32 v85, 0xffff0000, v81
    v_lshlrev_b32 v88, 16, v65
    v_and_b32 v89, 0xffff0000, v65
    v_add_f32 v82, v82, v86
    v_add_f32 v83, v83, v87
    v_add_f32 v84, v84, v88
    v_add_f32 v85, v85, v89
    v_cvt_pk_bf16_f32 v76, v82, v83
    v_cvt_pk_bf16_f32 v77, v84, v85
    v_cvt_pk_bf16_f32 v80, v20, v21
    v_cvt_pk_bf16_f32 v81, v22, v23
    v_lshlrev_b32 v82, 16, v80
    v_and_b32 v83, 0xffff0000, v80
    v_lshlrev_b32 v86, 16, v58
    v_and_b32 v87, 0xffff0000, v58
    v_lshlrev_b32 v84, 16, v81
    v_and_b32 v85, 0xffff0000, v81
    v_lshlrev_b32 v88, 16, v59
    v_and_b32 v89, 0xffff0000, v59
    v_mul_f32 v82, v82, v86
    v_mul_f32 v83, v83, v87
    v_mul_f32 v84, v84, v88
    v_mul_f32 v85, v85, v89
    v_cvt_pk_bf16_f32 v80, v82, v83
    v_cvt_pk_bf16_f32 v81, v84, v85
    v_lshlrev_b32 v82, 16, v80
    v_and_b32 v83, 0xffff0000, v80
    v_lshlrev_b32 v86, 16, v66
    v_and_b32 v87, 0xffff0000, v66
    v_lshlrev_b32 v84, 16, v81
    v_and_b32 v85, 0xffff0000, v81
    v_lshlrev_b32 v88, 16, v67
    v_and_b32 v89, 0xffff0000, v67
    v_add_f32 v82, v82, v86
    v_add_f32 v83, v83, v87
    v_add_f32 v84, v84, v88
    v_add_f32 v85, v85, v89
    v_cvt_pk_bf16_f32 v78, v82, v83
    v_cvt_pk_bf16_f32 v79, v84, v85
    s_nop 1
    v_permlane32_swap_b32 v76, v78
    v_permlane32_swap_b32 v77, v79
    buffer_store_dwordx4 v[76:79], v68, s[32:35], s65 offen offset:32
k3_end:
    s_waitcnt vmcnt(0)
k3_done:
    s_endpgm
.section .rodata,"a"
.p2align 6
.amdhsa_kernel gemm1_kernel
  .amdhsa_next_free_vgpr 120
  .amdhsa_next_free_sgpr 96
  .amdhsa_accum_offset 120
  .amdhsa_group_segment_fixed_size 0
  .amdhsa_kernarg_size 88
  .amdhsa_user_sgpr_count 2
  .amdhsa_user_sgpr_kernarg_segment_ptr 1
  .amdhsa_system_sgpr_workgroup_id_x 1
.end_amdhsa_kernel
.p2align 6
.amdhsa_kernel attn_kernel
  .amdhsa_next_free_vgpr 128
  .amdhsa_next_free_sgpr 96
  .amdhsa_accum_offset 128
  .amdhsa_group_segment_fixed_size 0
  .amdhsa_kernarg_size 88
  .amdhsa_user_sgpr_count 2
  .amdhsa_user_sgpr_kernarg_segment_ptr 1
  .amdhsa_system_sgpr_workgroup_id_x 1
.end_amdhsa_kernel
.p2align 6
.amdhsa_kernel out_kernel
  .amdhsa_next_free_vgpr 160
  .amdhsa_next_free_sgpr 96
  .amdhsa_accum_offset 160
  .amdhsa_group_segment_fixed_size 0
  .amdhsa_kernarg_size 88
  .amdhsa_user_sgpr_count 2
  .amdhsa_user_sgpr_kernarg_segment_ptr 1
  .amdhsa_system_sgpr_workgroup_id_x 1
.end_amdhsa_kernel
```
